```python
import torch

def _softmax(x, axis=-1):
    return torch.softmax(x, dim=axis)
def _gelu(x):
    return torch.nn.functional.gelu(x, approximate="tanh")
def _silu(x):
    return torch.nn.functional.silu(x)
def _sigmoid(x):
    return torch.sigmoid(x)
def _layernorm(x, axis=-1, eps=1e-5):
    m = x.mean(dim=axis, keepdim=True)
    v = x.var(dim=axis, keepdim=True, unbiased=False)
    return (x - m) / torch.sqrt(v + eps)
def _scatter_add(tgt, idx, src, axis=0):
    return tgt.clone().index_add_(axis, idx, src)
def _segment_sum(src, seg, n):
    out = torch.zeros((n,) + src.shape[1:], dtype=src.dtype)
    return out.index_add_(0, seg, src)
def _pad(x, pw):
    flat = tuple(v for pair in reversed(pw) for v in pair)
    return torch.nn.functional.pad(x, flat)

kernel_name = 'concat_heads__mha_block_cached__mha_block_cached__near_ridge'

def setup_inputs():

    _w = (lambda a: (lambda t: t.to(torch.bfloat16) if t.is_floating_point() else t)(torch.as_tensor(a)))
    def _A_setup():
        B, Sq, D = 8, 208, 512
        H, Sk, Dh = 32, 512, 128
        return {
            "x": _w((lambda *s: torch.randn(*s, dtype=torch.bfloat16) * 0.8)(B, Sq, D)),
            "k_cache": _w((lambda *s: torch.randn(*s, dtype=torch.bfloat16) * 0.8)(B, H, Sk, Dh)),
            "v_cache": _w((lambda *s: torch.randn(*s, dtype=torch.bfloat16) * 0.05)(B, H, Sk, Dh)),
            "wq": _w((lambda *s: torch.randn(*s, dtype=torch.bfloat16) * 0.8)(D, H * Dh) * (D ** -0.5)),
            "wo": _w((lambda *s: torch.randn(*s, dtype=torch.bfloat16) * 0.05)(H * Dh, D) * ((H * Dh) ** -0.5)),
        }
    _A_in = _A_setup()

    def _B_setup():
        B, Sq, D = 8, 208, 512
        H, Sk, Dh = 32, 512, 128
        return {
            "x": _w((lambda *s: torch.randn(*s, dtype=torch.bfloat16) * 0.8)(B, Sq, D)),
            "k_cache": _w((lambda *s: torch.randn(*s, dtype=torch.bfloat16) * 0.8)(B, H, Sk, Dh)),
            "v_cache": _w((lambda *s: torch.randn(*s, dtype=torch.bfloat16) * 0.05)(B, H, Sk, Dh)),
            "wq": _w((lambda *s: torch.randn(*s, dtype=torch.bfloat16) * 0.8)(D, H * Dh) * (D ** -0.5)),
            "wo": _w((lambda *s: torch.randn(*s, dtype=torch.bfloat16) * 0.05)(H * Dh, D) * ((H * Dh) ** -0.5)),
        }
    _B_in = _B_setup()

    return {
        "A_x": _A_in["x"],
        "A_k_cache": _A_in["k_cache"],
        "A_v_cache": _A_in["v_cache"],
        "A_wq": _A_in["wq"],
        "A_wo": _A_in["wo"],
        "B_x": _B_in["x"],
        "B_k_cache": _B_in["k_cache"],
        "B_v_cache": _B_in["v_cache"],
        "B_wq": _B_in["wq"],
        "B_wo": _B_in["wo"],
    }

def reference(A_x, A_k_cache, A_v_cache, A_wq, A_wo, B_x, B_k_cache, B_v_cache, B_wq, B_wo):
    def _A_ref(x, k_cache, v_cache, wq, wo):
        B, Sq, D = x.shape
        H, Dh = 32, 128
        q = (lambda x, *d: x.permute(*d))((x @ wq).reshape(B, Sq, H, Dh), 0, 2, 1, 3)
        scores = torch.einsum("bhqd,bhkd->bhqk", q, k_cache) * (Dh ** -0.5)
        p = _softmax(scores, axis=-1)
        o = torch.einsum("bhqk,bhkd->bhqd", p, v_cache)
        return (lambda x, *d: x.permute(*d))(o, 0, 2, 1, 3).reshape(B, Sq, H * Dh) @ wo

    def _B_ref(x, k_cache, v_cache, wq, wo):
        B, Sq, D = x.shape
        H, Dh = 32, 128
        q = (lambda x, *d: x.permute(*d))((x @ wq).reshape(B, Sq, H, Dh), 0, 2, 1, 3)
        scores = torch.einsum("bhqd,bhkd->bhqk", q, k_cache) * (Dh ** -0.5)
        p = _softmax(scores, axis=-1)
        o = torch.einsum("bhqk,bhkd->bhqd", p, v_cache)
        return (lambda x, *d: x.permute(*d))(o, 0, 2, 1, 3).reshape(B, Sq, H * Dh) @ wo

    a = _A_ref(A_x, A_k_cache, A_v_cache, A_wq, A_wo)
    b = _B_ref(B_x, B_k_cache, B_v_cache, B_wq, B_wo)
    return torch.concatenate([a, b], axis=-1)
```

```asm
; @launch kernel=mha_kernel grid=(256,1,1) block=(512,1,1) lds=163840
; @launch kernel=oproj_kernel grid=(256,1,1) block=(512,1,1) lds=106496
; @launch kernel=reduce_kernel grid=(832,1,1) block=(256,1,1) lds=0
.amdgcn_target "amdgcn-amd-amdhsa--gfx950"
.text
.globl mha_kernel
.p2align 8
.type mha_kernel,@function
mha_kernel:
    s_cmp_ge_u32 s2, 0x100
    s_cbranch_scc1 k_end
    s_and_b32 s69, s2, 7
    s_lshr_b32 s70, s2, 3
    s_lshr_b32 s56, s69, 2
    s_and_b32 s57, s69, 3
    s_lshr_b32 s58, s70, 2
    s_and_b32 s59, s70, 3
    s_mul_i32 s69, s56, 40
    s_add_u32 s72, s0, s69
    s_addc_u32 s73, s1, 0
    s_load_dwordx8 s[40:47], s[72:73], 0
    s_load_dwordx2 s[48:49], s[72:73], 32
    s_load_dwordx4 s[52:55], s[0:1], 0x58
    s_load_dwordx2 s[50:51], s[0:1], 0x50
    v_lshrrev_b32 v7, 6, v0
    s_nop 0
    v_readfirstlane_b32 s62, v7
    v_and_b32 v0, 63, v0
    s_lshr_b32 s60, s62, 2
    s_and_b32 s61, s62, 3
    s_mul_i32 s71, s61, 0x840
    s_mul_i32 s63, s61, 3
    s_cmp_gt_u32 s61, s60
    s_addc_u32 s63, s63, 0
    s_mov_b32 s64, 0x3e0293ee
    s_mov_b32 s100, 0x3e0293ee
    s_mov_b32 s101, 0x3e0293ee
    s_mov_b32 s65, 0xbe0293ee
    s_mov_b32 s66, 0x45800000
    s_mul_i32 s70, s60, 0x8400
    v_lshrrev_b32 v11, 2, v0
    v_and_b32 v11, 3, v11
    v_lshrrev_b32 v10, 4, v0
    v_and_b32 v10, 3, v10
    v_and_b32 v10, 1, v10
    v_lshlrev_b32 v10, 2, v10
    v_add_u32 v11, v11, v10
    v_mul_u32_u24 v11, 0x420, v11
    v_lshrrev_b32 v10, 4, v0
    v_and_b32 v10, 3, v10
    v_lshrrev_b32 v10, 1, v10
    v_mul_u32_u24 v10, 0x200, v10
    v_add_u32 v11, v11, v10
    v_and_b32 v10, 3, v0
    v_mul_u32_u24 v10, 8, v10
    v_add_u32 v11, v11, v10
    v_add_u32 v11, s70, v11
    v_add_u32 v12, 0x8400, v11
    v_lshrrev_b32 v11, 4, v0
    v_and_b32 v11, 3, v11
    v_and_b32 v11, 1, v11
    v_mov_b32 v9, s61
    v_mul_u32_u24 v10, 2, v9
    v_add_u32 v10, 4, v10
    v_mul_u32_u24 v11, v11, v10
    v_lshrrev_b32 v10, 4, v0
    v_and_b32 v10, 3, v10
    v_and_b32 v10, 1, v10
    v_xor_b32 v10, 1, v10
    v_mov_b32 v8, s61
    v_mul_u32_u24 v9, 2, v8
    v_mov_b32 v7, s61
    v_mul_u32_u24 v8, 2, v7
    v_lshrrev_b32 v8, 2, v8
    v_lshlrev_b32 v8, 3, v8
    v_add_u32 v9, v9, v8
    v_mul_u32_u24 v10, v10, v9
    v_add_u32 v11, v11, v10
    v_lshrrev_b32 v10, 4, v0
    v_and_b32 v10, 3, v10
    v_lshrrev_b32 v10, 1, v10
    v_lshlrev_b32 v10, 4, v10
    v_add_u32 v11, v11, v10
    v_mul_u32_u24 v11, 0x100, v11
    v_and_b32 v10, 15, v0
    v_mul_u32_u24 v10, 16, v10
    v_add_u32 v3, v11, v10
    v_mov_b32 v11, s61
    v_mul_u32_u24 v10, 2, v11
    v_lshrrev_b32 v11, 4, v0
    v_and_b32 v11, 3, v11
    v_lshlrev_b32 v11, 3, v11
    v_add_u32 v10, v10, v11
    v_mul_u32_u24 v10, 0x100, v10
    v_and_b32 v11, 15, v0
    v_mul_u32_u24 v11, 16, v11
    v_add_u32 v4, v10, v11
    v_mov_b32 v10, s61
    v_mul_u32_u24 v11, 2, v10
    v_and_b32 v11, 3, v11
    v_mov_b32 v9, s61
    v_mul_u32_u24 v10, 2, v9
    v_lshrrev_b32 v10, 2, v10
    v_lshlrev_b32 v10, 3, v10
    v_add_u32 v11, v11, v10
    v_lshrrev_b32 v10, 4, v0
    v_and_b32 v10, 3, v10
    v_and_b32 v10, 1, v10
    v_lshlrev_b32 v10, 2, v10
    v_add_u32 v11, v11, v10
    v_lshrrev_b32 v10, 4, v0
    v_and_b32 v10, 3, v10
    v_lshrrev_b32 v10, 1, v10
    v_lshlrev_b32 v10, 4, v10
    v_add_u32 v11, v11, v10
    v_mul_u32_u24 v11, 0x2000, v11
    v_and_b32 v10, 15, v0
    v_mul_u32_u24 v10, 16, v10
    v_add_u32 v5, v11, v10
    v_lshrrev_b32 v10, 2, v0
    v_mul_u32_u24 v10, 0x400, v10
    v_and_b32 v11, 3, v0
    v_lshrrev_b32 v9, 2, v0
    v_lshrrev_b32 v9, 2, v9
    v_sub_u32 v9, 4, v9
    v_and_b32 v9, 3, v9
    v_xor_b32 v11, v11, v9
    v_lshlrev_b32 v11, 4, v11
    v_add_u32 v6, v10, v11
    v_mov_b32 v10, s63
    v_lshlrev_b32 v11, 10, v10
    v_and_b32 v10, 15, v0
    v_mul_u32_u24 v10, 64, v10
    v_add_u32 v11, v11, v10
    v_lshrrev_b32 v10, 4, v0
    v_and_b32 v9, 15, v0
    v_lshrrev_b32 v9, 2, v9
    v_sub_u32 v9, 4, v9
    v_and_b32 v9, 3, v9
    v_xor_b32 v10, v10, v9
    v_lshlrev_b32 v10, 4, v10
    v_add_u32 v11, v11, v10
    v_add_u32 v13, 0x18c00, v11
    s_waitcnt lgkmcnt(0)
    s_add_u32 s81, s71, s70
    s_add_u32 s81, s81, 0x8400
    s_mul_i32 s80, s60, 0x4200
    s_add_u32 s80, s80, s71
    s_mov_b32 s78, s62
    s_cmp_gt_u32 s62, 0
    s_subb_u32 s78, s78, 0
    s_cmp_gt_u32 s62, 5
    s_subb_u32 s78, s78, 0
    s_lshl_b32 s78, s78, 1
    s_cmp_eq_u32 s61, s60
    s_cselect_b32 s78, 12, s78
    s_add_u32 s79, s78, 1
    s_lshl_b32 s78, s78, 14
    s_lshl_b32 s79, s79, 14
    s_lshr_b32 s73, s2, 2
    s_and_b32 s73, s73, 14
    s_lshl_b32 s69, s57, 3
    s_lshl_b32 s70, s59, 1
    s_add_u32 s69, s69, s70
    s_add_u32 s72, s69, s60
    s_mul_i32 s69, s58, 0x34000
    s_add_u32 s4, s40, s69
    s_addc_u32 s5, s41, 0
    s_and_b32 s5, s5, 0xffff
    s_mov_b32 s6, 0x34000
    s_mov_b32 s7, 0x20000
    s_lshl_b32 s69, s58, 5
    s_add_u32 s69, s69, s72
    s_lshl_b32 s70, s69, 17
    s_add_u32 s12, s42, s70
    s_addc_u32 s13, s43, 0
    s_and_b32 s13, s13, 0xffff
    s_mov_b32 s14, 0x20000
    s_mov_b32 s15, 0x20000
    s_add_u32 s16, s44, s70
    s_addc_u32 s17, s45, 0
    s_and_b32 s17, s17, 0xffff
    s_mov_b32 s18, 0x20000
    s_mov_b32 s19, 0x20000
    s_lshl_b32 s70, s56, 8
    s_add_u32 s69, s69, s70
    s_mul_i32 s69, s69, 0xd000
    s_add_u32 s20, s54, s69
    s_addc_u32 s21, s55, 0
    s_and_b32 s21, s21, 0xffff
    s_mov_b32 s22, 0xd000
    s_mov_b32 s23, 0x20000
    s_lshl_b32 s69, s72, 8
    s_sub_u32 s70, 0x400000, s69
    s_add_u32 s8, s46, s69
    s_addc_u32 s9, s47, 0
    s_and_b32 s9, s9, 0xffff
    s_mov_b32 s10, s70
    s_mov_b32 s11, 0x20000
    s_lshl_b32 s69, s57, 4
    s_lshl_b32 s70, s56, 3
    s_add_u32 s69, s69, s70
    s_add_u32 s69, s69, s58
    s_lshl_b32 s69, s69, 2
    s_add_u32 s69, s69, s59
    s_mul_i32 s69, s69, 0x1a000
    s_add_u32 s69, s69, 0x2000000
    s_add_u32 s24, s54, s69
    s_addc_u32 s25, s55, 0
    s_and_b32 s25, s25, 0xffff
    s_mov_b32 s26, 0x1a000
    s_mov_b32 s27, 0x20000
    s_add_u32 s28, s50, 0
    s_addc_u32 s29, s51, 0
    s_and_b32 s29, s29, 0xffff
    s_mov_b32 s30, 0x340000
    s_mov_b32 s31, 0x20000
    s_add_u32 s32, s52, 0
    s_addc_u32 s33, s53, 0
    s_and_b32 s33, s33, 0xffff
    s_mov_b32 s34, 0x100
    s_mov_b32 s35, 0x20000
    s_cmp_eq_u32 s61, s60
    s_cbranch_scc0 k_nt3
    s_lshl_b32 s74, s73, 18
    s_lshl_b32 s75, s73, 6
    s_add_u32 m0, s81, 0
    s_nop 0
    buffer_load_dwordx4 v5, s[8:11], s74 offen lds
    s_add_u32 m0, s81, 0x420
    s_add_u32 s69, s74, 0x2000
    buffer_load_dwordx4 v5, s[8:11], s69 offen lds
    s_lshr_b32 s69, s78, 4
    s_add_u32 m0, s69, 0x18c00
    s_add_u32 s69, s78, s75
    buffer_load_dwordx4 v6, s[4:7], s69 offen lds
    s_add_u32 s73, s73, 1
    s_and_b32 s73, s73, 15
    s_lshl_b32 s74, s73, 18
    s_lshl_b32 s75, s73, 6
    s_add_u32 m0, s81, 0x2100
    s_nop 0
    buffer_load_dwordx4 v5, s[8:11], s74 offen lds
    s_add_u32 m0, s81, 0x2520
    s_add_u32 s69, s74, 0x2000
    buffer_load_dwordx4 v5, s[8:11], s69 offen lds
    s_lshr_b32 s69, s78, 4
    s_add_u32 m0, s69, 0x1c000
    s_add_u32 s69, s78, s75
    buffer_load_dwordx4 v6, s[4:7], s69 offen lds
    s_add_u32 s73, s73, 1
    s_and_b32 s73, s73, 15
    s_lshl_b32 s74, s73, 18
    s_lshl_b32 s75, s73, 6
    s_add_u32 m0, s81, 0x4200
    s_nop 0
    buffer_load_dwordx4 v5, s[8:11], s74 offen lds
    s_add_u32 m0, s81, 0x4620
    s_add_u32 s69, s74, 0x2000
    buffer_load_dwordx4 v5, s[8:11], s69 offen lds
    s_lshr_b32 s69, s78, 4
    s_add_u32 m0, s69, 0x1f400
    s_add_u32 s69, s78, s75
    buffer_load_dwordx4 v6, s[4:7], s69 offen lds
    s_mov_b32 s70, 0
    s_add_u32 m0, s80, 0
    s_nop 0
    buffer_load_dwordx4 v3, s[12:15], s70 offen nt lds
    s_add_u32 m0, s80, 0x310
    s_nop 0
    buffer_load_dwordx4 v3, s[12:15], s70 offen offset:256 nt lds
    s_add_u32 m0, s80, 0x2100
    s_nop 0
    buffer_load_dwordx4 v4, s[16:19], s70 offen nt lds
    s_add_u32 m0, s80, 0x2420
    s_nop 0
    buffer_load_dwordx4 v4, s[16:19], s70 offen offset:256 nt lds
    v_mov_b32 v128, 0
    v_mov_b32 v129, 0
    v_mov_b32 v130, 0
    v_mov_b32 v131, 0
    v_mov_b32 v132, 0
    v_mov_b32 v133, 0
    v_mov_b32 v134, 0
    v_mov_b32 v135, 0
    v_mov_b32 v136, 0
    v_mov_b32 v137, 0
    v_mov_b32 v138, 0
    v_mov_b32 v139, 0
    v_mov_b32 v140, 0
    v_mov_b32 v141, 0
    v_mov_b32 v142, 0
    v_mov_b32 v143, 0
    v_mov_b32 v144, 0
    v_mov_b32 v145, 0
    v_mov_b32 v146, 0
    v_mov_b32 v147, 0
    v_mov_b32 v148, 0
    v_mov_b32 v149, 0
    v_mov_b32 v150, 0
    v_mov_b32 v151, 0
    v_mov_b32 v152, 0
    v_mov_b32 v153, 0
    v_mov_b32 v154, 0
    v_mov_b32 v155, 0
    v_mov_b32 v156, 0
    v_mov_b32 v157, 0
    v_mov_b32 v158, 0
    v_mov_b32 v159, 0
    v_mov_b32 v160, 0
    v_mov_b32 v161, 0
    v_mov_b32 v162, 0
    v_mov_b32 v163, 0
    v_mov_b32 v164, 0
    v_mov_b32 v165, 0
    v_mov_b32 v166, 0
    v_mov_b32 v167, 0
    v_mov_b32 v168, 0
    v_mov_b32 v169, 0
    v_mov_b32 v170, 0
    v_mov_b32 v171, 0
    v_mov_b32 v172, 0
    v_mov_b32 v173, 0
    v_mov_b32 v174, 0
    v_mov_b32 v175, 0
    v_mov_b32 v176, 0
    v_mov_b32 v177, 0
    v_mov_b32 v178, 0
    v_mov_b32 v179, 0
    v_mov_b32 v180, 0
    v_mov_b32 v181, 0
    v_mov_b32 v182, 0
    v_mov_b32 v183, 0
    v_mov_b32 v184, 0
    v_mov_b32 v185, 0
    v_mov_b32 v186, 0
    v_mov_b32 v187, 0
    v_mov_b32 v188, 0
    v_mov_b32 v189, 0
    v_mov_b32 v190, 0
    v_mov_b32 v191, 0
    v_mov_b32 v192, 0
    v_mov_b32 v193, 0
    v_mov_b32 v194, 0
    v_mov_b32 v195, 0
    v_mov_b32 v196, 0
    v_mov_b32 v197, 0
    v_mov_b32 v198, 0
    v_mov_b32 v199, 0
    v_mov_b32 v200, 0
    v_mov_b32 v201, 0
    v_mov_b32 v202, 0
    v_mov_b32 v203, 0
    v_mov_b32 v204, 0
    v_mov_b32 v205, 0
    v_mov_b32 v206, 0
    v_mov_b32 v207, 0
    v_mov_b32 v208, 0
    v_mov_b32 v209, 0
    v_mov_b32 v210, 0
    v_mov_b32 v211, 0
    v_mov_b32 v212, 0
    v_mov_b32 v213, 0
    v_mov_b32 v214, 0
    v_mov_b32 v215, 0
    v_mov_b32 v216, 0
    v_mov_b32 v217, 0
    v_mov_b32 v218, 0
    v_mov_b32 v219, 0
    v_mov_b32 v220, 0
    v_mov_b32 v221, 0
    v_mov_b32 v222, 0
    v_mov_b32 v223, 0
    v_mov_b32 v224, 0
    v_mov_b32 v225, 0
    v_mov_b32 v226, 0
    v_mov_b32 v227, 0
    v_mov_b32 v228, 0
    v_mov_b32 v229, 0
    v_mov_b32 v230, 0
    v_mov_b32 v231, 0
    v_mov_b32 v232, 0
    v_mov_b32 v233, 0
    v_mov_b32 v234, 0
    v_mov_b32 v235, 0
    v_mov_b32 v236, 0
    v_mov_b32 v237, 0
    v_mov_b32 v238, 0
    v_mov_b32 v239, 0
    v_mov_b32 v240, 0
    v_mov_b32 v241, 0
    v_mov_b32 v242, 0
    v_mov_b32 v243, 0
    v_mov_b32 v244, 0
    v_mov_b32 v245, 0
    v_mov_b32 v246, 0
    v_mov_b32 v247, 0
    v_mov_b32 v248, 0
    v_mov_b32 v249, 0
    v_mov_b32 v250, 0
    v_mov_b32 v251, 0
    v_mov_b32 v252, 0
    v_mov_b32 v253, 0
    v_mov_b32 v254, 0
    v_mov_b32 v255, 0
    s_mov_b32 s72, 0
    s_mov_b32 s82, 0
    s_mov_b32 s67, 0
    s_waitcnt vmcnt(10)
    s_barrier
    ds_read_b128 v[32:35], v13 offset:0
    ds_read_b128 v[36:39], v13 offset:1024
    ds_read_b128 v[40:43], v13 offset:2048
    ds_read_b128 v[44:47], v13 offset:3072
    ds_read_b64_tr_b16 v[64:65], v12 offset:0
    ds_read_b64_tr_b16 v[66:67], v12 offset:256
    ds_read_b64_tr_b16 v[68:69], v12 offset:32
    ds_read_b64_tr_b16 v[70:71], v12 offset:288
    ds_read_b64_tr_b16 v[72:73], v12 offset:64
    ds_read_b64_tr_b16 v[74:75], v12 offset:320
    v_mov_b32 v14, v12
    v_add_u32 v15, 0x3400, v13
p1_loop_4:
    s_cmp_eq_u32 s67, 0
    s_cbranch_scc1 p1_w0_4
    s_waitcnt vmcnt(3)
p1_w0_4:
    s_waitcnt vmcnt(7)
    s_barrier
    s_waitcnt lgkmcnt(4)
    v_mfma_f32_16x16x32_bf16 v[128:131], v[64:67], v[32:35], v[128:131]
    v_mfma_f32_16x16x32_bf16 v[132:135], v[64:67], v[36:39], v[132:135]
    v_mfma_f32_16x16x32_bf16 v[136:139], v[64:67], v[40:43], v[136:139]
    v_mfma_f32_16x16x32_bf16 v[140:143], v[64:67], v[44:47], v[140:143]
    ds_read_b64_tr_b16 v[76:77], v14 offset:96
    ds_read_b64_tr_b16 v[78:79], v14 offset:352
    ds_read_b128 v[48:51], v15 offset:0
    ds_read_b128 v[52:55], v15 offset:1024
    ds_read_b128 v[56:59], v15 offset:2048
    ds_read_b128 v[60:63], v15 offset:3072
    s_mul_i32 s77, s72, 0x3400
    s_add_u32 s77, s77, 0x18c00
    s_add_u32 s76, s82, 0x6300
    s_cmp_ge_u32 s76, 0x8400
    s_cselect_b32 s69, 0x8400, 0
    s_sub_u32 s76, s76, s69
    s_add_u32 s76, s76, s81
    s_add_u32 s82, s82, 0x2100
    s_cmp_eq_u32 s82, 0x8400
    s_cselect_b32 s82, 0, s82
    v_add_u32 v16, s82, v12
    s_add_u32 s73, s73, 1
    s_and_b32 s73, s73, 15
    s_lshl_b32 s74, s73, 18
    s_lshl_b32 s75, s73, 6
    s_waitcnt lgkmcnt(8)
    v_mfma_f32_16x16x32_bf16 v[144:147], v[68:71], v[32:35], v[144:147]
    v_mfma_f32_16x16x32_bf16 v[148:151], v[68:71], v[36:39], v[148:151]
    v_mfma_f32_16x16x32_bf16 v[152:155], v[68:71], v[40:43], v[152:155]
    v_mfma_f32_16x16x32_bf16 v[156:159], v[68:71], v[44:47], v[156:159]
    ds_read_b64_tr_b16 v[64:65], v14 offset:128
    ds_read_b64_tr_b16 v[66:67], v14 offset:384
    s_add_u32 m0, s76, 0
    s_nop 0
    buffer_load_dwordx4 v5, s[8:11], s74 offen lds
    s_waitcnt lgkmcnt(8)
    v_mfma_f32_16x16x32_bf16 v[160:163], v[72:75], v[32:35], v[160:163]
    v_mfma_f32_16x16x32_bf16 v[164:167], v[72:75], v[36:39], v[164:167]
    v_mfma_f32_16x16x32_bf16 v[168:171], v[72:75], v[40:43], v[168:171]
    v_mfma_f32_16x16x32_bf16 v[172:175], v[72:75], v[44:47], v[172:175]
    ds_read_b64_tr_b16 v[68:69], v14 offset:160
    ds_read_b64_tr_b16 v[70:71], v14 offset:416
    s_add_u32 m0, s76, 0x420
    s_add_u32 s69, s74, 0x2000
    buffer_load_dwordx4 v5, s[8:11], s69 offen lds
    s_waitcnt lgkmcnt(8)
    v_mfma_f32_16x16x32_bf16 v[176:179], v[76:79], v[32:35], v[176:179]
    v_mfma_f32_16x16x32_bf16 v[180:183], v[76:79], v[36:39], v[180:183]
    v_mfma_f32_16x16x32_bf16 v[184:187], v[76:79], v[40:43], v[184:187]
    v_mfma_f32_16x16x32_bf16 v[188:191], v[76:79], v[44:47], v[188:191]
    ds_read_b64_tr_b16 v[72:73], v14 offset:192
    ds_read_b64_tr_b16 v[74:75], v14 offset:448
    s_waitcnt lgkmcnt(4)
    v_mfma_f32_16x16x32_bf16 v[192:195], v[64:67], v[32:35], v[192:195]
    v_mfma_f32_16x16x32_bf16 v[196:199], v[64:67], v[36:39], v[196:199]
    v_mfma_f32_16x16x32_bf16 v[200:203], v[64:67], v[40:43], v[200:203]
    v_mfma_f32_16x16x32_bf16 v[204:207], v[64:67], v[44:47], v[204:207]
    ds_read_b64_tr_b16 v[76:77], v14 offset:224
    ds_read_b64_tr_b16 v[78:79], v14 offset:480
    s_lshr_b32 s69, s78, 4
    s_add_u32 m0, s69, s77
    s_add_u32 s69, s78, s75
    buffer_load_dwordx4 v6, s[4:7], s69 offen lds
    s_waitcnt lgkmcnt(4)
    v_mfma_f32_16x16x32_bf16 v[208:211], v[68:71], v[32:35], v[208:211]
    v_mfma_f32_16x16x32_bf16 v[212:215], v[68:71], v[36:39], v[212:215]
    v_mfma_f32_16x16x32_bf16 v[216:219], v[68:71], v[40:43], v[216:219]
    v_mfma_f32_16x16x32_bf16 v[220:223], v[68:71], v[44:47], v[220:223]
    ds_read_b64_tr_b16 v[64:65], v16 offset:0
    ds_read_b64_tr_b16 v[66:67], v16 offset:256
    s_waitcnt lgkmcnt(4)
    v_mfma_f32_16x16x32_bf16 v[224:227], v[72:75], v[32:35], v[224:227]
    v_mfma_f32_16x16x32_bf16 v[228:231], v[72:75], v[36:39], v[228:231]
    v_mfma_f32_16x16x32_bf16 v[232:235], v[72:75], v[40:43], v[232:235]
    v_mfma_f32_16x16x32_bf16 v[236:239], v[72:75], v[44:47], v[236:239]
    ds_read_b64_tr_b16 v[68:69], v16 offset:32
    ds_read_b64_tr_b16 v[70:71], v16 offset:288
    s_add_u32 s72, s72, 1
    s_cmp_eq_u32 s72, 3
    s_cselect_b32 s72, 0, s72
    s_add_u32 s69, s72, 1
    s_cmp_eq_u32 s69, 3
    s_cselect_b32 s69, 0, s69
    s_mul_i32 s69, s69, 0x3400
    v_add_u32 v15, s69, v13
    s_waitcnt lgkmcnt(4)
    v_mfma_f32_16x16x32_bf16 v[240:243], v[76:79], v[32:35], v[240:243]
    v_mfma_f32_16x16x32_bf16 v[244:247], v[76:79], v[36:39], v[244:247]
    v_mfma_f32_16x16x32_bf16 v[248:251], v[76:79], v[40:43], v[248:251]
    v_mfma_f32_16x16x32_bf16 v[252:255], v[76:79], v[44:47], v[252:255]
    ds_read_b64_tr_b16 v[72:73], v16 offset:64
    ds_read_b64_tr_b16 v[74:75], v16 offset:320
    v_mov_b32 v14, v16
    s_cmp_eq_u32 s67, 0
    s_cbranch_scc1 p1_w1_4
    s_waitcnt vmcnt(3)
p1_w1_4:
    s_waitcnt vmcnt(7)
    s_barrier
    s_waitcnt lgkmcnt(4)
    v_mfma_f32_16x16x32_bf16 v[128:131], v[64:67], v[48:51], v[128:131]
    v_mfma_f32_16x16x32_bf16 v[132:135], v[64:67], v[52:55], v[132:135]
    v_mfma_f32_16x16x32_bf16 v[136:139], v[64:67], v[56:59], v[136:139]
    v_mfma_f32_16x16x32_bf16 v[140:143], v[64:67], v[60:63], v[140:143]
    ds_read_b64_tr_b16 v[76:77], v14 offset:96
    ds_read_b64_tr_b16 v[78:79], v14 offset:352
    ds_read_b128 v[32:35], v15 offset:0
    ds_read_b128 v[36:39], v15 offset:1024
    ds_read_b128 v[40:43], v15 offset:2048
    ds_read_b128 v[44:47], v15 offset:3072
    s_mul_i32 s77, s72, 0x3400
    s_add_u32 s77, s77, 0x18c00
    s_add_u32 s76, s82, 0x6300
    s_cmp_ge_u32 s76, 0x8400
    s_cselect_b32 s69, 0x8400, 0
    s_sub_u32 s76, s76, s69
    s_add_u32 s76, s76, s81
    s_add_u32 s82, s82, 0x2100
    s_cmp_eq_u32 s82, 0x8400
    s_cselect_b32 s82, 0, s82
    v_add_u32 v16, s82, v12
    s_add_u32 s73, s73, 1
    s_and_b32 s73, s73, 15
    s_lshl_b32 s74, s73, 18
    s_lshl_b32 s75, s73, 6
    s_waitcnt lgkmcnt(8)
    v_mfma_f32_16x16x32_bf16 v[144:147], v[68:71], v[48:51], v[144:147]
    v_mfma_f32_16x16x32_bf16 v[148:151], v[68:71], v[52:55], v[148:151]
    v_mfma_f32_16x16x32_bf16 v[152:155], v[68:71], v[56:59], v[152:155]
    v_mfma_f32_16x16x32_bf16 v[156:159], v[68:71], v[60:63], v[156:159]
    ds_read_b64_tr_b16 v[64:65], v14 offset:128
    ds_read_b64_tr_b16 v[66:67], v14 offset:384
    s_add_u32 m0, s76, 0
    s_nop 0
    buffer_load_dwordx4 v5, s[8:11], s74 offen lds
    s_waitcnt lgkmcnt(8)
    v_mfma_f32_16x16x32_bf16 v[160:163], v[72:75], v[48:51], v[160:163]
    v_mfma_f32_16x16x32_bf16 v[164:167], v[72:75], v[52:55], v[164:167]
    v_mfma_f32_16x16x32_bf16 v[168:171], v[72:75], v[56:59], v[168:171]
    v_mfma_f32_16x16x32_bf16 v[172:175], v[72:75], v[60:63], v[172:175]
    ds_read_b64_tr_b16 v[68:69], v14 offset:160
    ds_read_b64_tr_b16 v[70:71], v14 offset:416
    s_add_u32 m0, s76, 0x420
    s_add_u32 s69, s74, 0x2000
    buffer_load_dwordx4 v5, s[8:11], s69 offen lds
    s_waitcnt lgkmcnt(8)
    v_mfma_f32_16x16x32_bf16 v[176:179], v[76:79], v[48:51], v[176:179]
    v_mfma_f32_16x16x32_bf16 v[180:183], v[76:79], v[52:55], v[180:183]
    v_mfma_f32_16x16x32_bf16 v[184:187], v[76:79], v[56:59], v[184:187]
    v_mfma_f32_16x16x32_bf16 v[188:191], v[76:79], v[60:63], v[188:191]
    ds_read_b64_tr_b16 v[72:73], v14 offset:192
    ds_read_b64_tr_b16 v[74:75], v14 offset:448
    s_waitcnt lgkmcnt(4)
    v_mfma_f32_16x16x32_bf16 v[192:195], v[64:67], v[48:51], v[192:195]
    v_mfma_f32_16x16x32_bf16 v[196:199], v[64:67], v[52:55], v[196:199]
    v_mfma_f32_16x16x32_bf16 v[200:203], v[64:67], v[56:59], v[200:203]
    v_mfma_f32_16x16x32_bf16 v[204:207], v[64:67], v[60:63], v[204:207]
    ds_read_b64_tr_b16 v[76:77], v14 offset:224
    ds_read_b64_tr_b16 v[78:79], v14 offset:480
    s_lshr_b32 s69, s78, 4
    s_add_u32 m0, s69, s77
    s_add_u32 s69, s78, s75
    buffer_load_dwordx4 v6, s[4:7], s69 offen lds
    s_waitcnt lgkmcnt(4)
    v_mfma_f32_16x16x32_bf16 v[208:211], v[68:71], v[48:51], v[208:211]
    v_mfma_f32_16x16x32_bf16 v[212:215], v[68:71], v[52:55], v[212:215]
    v_mfma_f32_16x16x32_bf16 v[216:219], v[68:71], v[56:59], v[216:219]
    v_mfma_f32_16x16x32_bf16 v[220:223], v[68:71], v[60:63], v[220:223]
    ds_read_b64_tr_b16 v[64:65], v16 offset:0
    ds_read_b64_tr_b16 v[66:67], v16 offset:256
    s_waitcnt lgkmcnt(4)
    v_mfma_f32_16x16x32_bf16 v[224:227], v[72:75], v[48:51], v[224:227]
    v_mfma_f32_16x16x32_bf16 v[228:231], v[72:75], v[52:55], v[228:231]
    v_mfma_f32_16x16x32_bf16 v[232:235], v[72:75], v[56:59], v[232:235]
    v_mfma_f32_16x16x32_bf16 v[236:239], v[72:75], v[60:63], v[236:239]
    ds_read_b64_tr_b16 v[68:69], v16 offset:32
    ds_read_b64_tr_b16 v[70:71], v16 offset:288
    s_add_u32 s72, s72, 1
    s_cmp_eq_u32 s72, 3
    s_cselect_b32 s72, 0, s72
    s_add_u32 s69, s72, 1
    s_cmp_eq_u32 s69, 3
    s_cselect_b32 s69, 0, s69
    s_mul_i32 s69, s69, 0x3400
    v_add_u32 v15, s69, v13
    s_waitcnt lgkmcnt(4)
    v_mfma_f32_16x16x32_bf16 v[240:243], v[76:79], v[48:51], v[240:243]
    v_mfma_f32_16x16x32_bf16 v[244:247], v[76:79], v[52:55], v[244:247]
    v_mfma_f32_16x16x32_bf16 v[248:251], v[76:79], v[56:59], v[248:251]
    v_mfma_f32_16x16x32_bf16 v[252:255], v[76:79], v[60:63], v[252:255]
    ds_read_b64_tr_b16 v[72:73], v16 offset:64
    ds_read_b64_tr_b16 v[74:75], v16 offset:320
    v_mov_b32 v14, v16
    s_add_u32 s67, s67, 1
    s_cmp_lt_u32 s67, 8
    s_cbranch_scc1 p1_loop_4
    s_waitcnt lgkmcnt(0)
    v_cvt_pk_bf16_f32 v64, v128, v129
    v_cvt_pk_bf16_f32 v65, v130, v131
    v_cvt_pk_bf16_f32 v66, v144, v145
    v_cvt_pk_bf16_f32 v67, v146, v147
    s_nop 0
    v_permlane16_swap_b32 v64, v66
    v_permlane16_swap_b32 v65, v67
    v_cvt_pk_bf16_f32 v68, v160, v161
    v_cvt_pk_bf16_f32 v69, v162, v163
    v_cvt_pk_bf16_f32 v70, v176, v177
    v_cvt_pk_bf16_f32 v71, v178, v179
    s_nop 0
    v_permlane16_swap_b32 v68, v70
    v_permlane16_swap_b32 v69, v71
    v_cvt_pk_bf16_f32 v72, v192, v193
    v_cvt_pk_bf16_f32 v73, v194, v195
    v_cvt_pk_bf16_f32 v74, v208, v209
    v_cvt_pk_bf16_f32 v75, v210, v211
    s_nop 0
    v_permlane16_swap_b32 v72, v74
    v_permlane16_swap_b32 v73, v75
    v_cvt_pk_bf16_f32 v76, v224, v225
    v_cvt_pk_bf16_f32 v77, v226, v227
    v_cvt_pk_bf16_f32 v78, v240, v241
    v_cvt_pk_bf16_f32 v79, v242, v243
    s_nop 0
    v_permlane16_swap_b32 v76, v78
    v_permlane16_swap_b32 v77, v79
    v_cvt_pk_bf16_f32 v80, v132, v133
    v_cvt_pk_bf16_f32 v81, v134, v135
    v_cvt_pk_bf16_f32 v82, v148, v149
    v_cvt_pk_bf16_f32 v83, v150, v151
    s_nop 0
    v_permlane16_swap_b32 v80, v82
    v_permlane16_swap_b32 v81, v83
    v_cvt_pk_bf16_f32 v84, v164, v165
    v_cvt_pk_bf16_f32 v85, v166, v167
    v_cvt_pk_bf16_f32 v86, v180, v181
    v_cvt_pk_bf16_f32 v87, v182, v183
    s_nop 0
    v_permlane16_swap_b32 v84, v86
    v_permlane16_swap_b32 v85, v87
    v_cvt_pk_bf16_f32 v88, v196, v197
    v_cvt_pk_bf16_f32 v89, v198, v199
    v_cvt_pk_bf16_f32 v90, v212, v213
    v_cvt_pk_bf16_f32 v91, v214, v215
    s_nop 0
    v_permlane16_swap_b32 v88, v90
    v_permlane16_swap_b32 v89, v91
    v_cvt_pk_bf16_f32 v92, v228, v229
    v_cvt_pk_bf16_f32 v93, v230, v231
    v_cvt_pk_bf16_f32 v94, v244, v245
    v_cvt_pk_bf16_f32 v95, v246, v247
    s_nop 0
    v_permlane16_swap_b32 v92, v94
    v_permlane16_swap_b32 v93, v95
    v_cvt_pk_bf16_f32 v96, v136, v137
    v_cvt_pk_bf16_f32 v97, v138, v139
    v_cvt_pk_bf16_f32 v98, v152, v153
    v_cvt_pk_bf16_f32 v99, v154, v155
    s_nop 0
    v_permlane16_swap_b32 v96, v98
    v_permlane16_swap_b32 v97, v99
    v_cvt_pk_bf16_f32 v100, v168, v169
    v_cvt_pk_bf16_f32 v101, v170, v171
    v_cvt_pk_bf16_f32 v102, v184, v185
    v_cvt_pk_bf16_f32 v103, v186, v187
    s_nop 0
    v_permlane16_swap_b32 v100, v102
    v_permlane16_swap_b32 v101, v103
    v_cvt_pk_bf16_f32 v104, v200, v201
    v_cvt_pk_bf16_f32 v105, v202, v203
    v_cvt_pk_bf16_f32 v106, v216, v217
    v_cvt_pk_bf16_f32 v107, v218, v219
    s_nop 0
    v_permlane16_swap_b32 v104, v106
    v_permlane16_swap_b32 v105, v107
    v_cvt_pk_bf16_f32 v108, v232, v233
    v_cvt_pk_bf16_f32 v109, v234, v235
    v_cvt_pk_bf16_f32 v110, v248, v249
    v_cvt_pk_bf16_f32 v111, v250, v251
    s_nop 0
    v_permlane16_swap_b32 v108, v110
    v_permlane16_swap_b32 v109, v111
    v_cvt_pk_bf16_f32 v112, v140, v141
    v_cvt_pk_bf16_f32 v113, v142, v143
    v_cvt_pk_bf16_f32 v114, v156, v157
    v_cvt_pk_bf16_f32 v115, v158, v159
    s_nop 0
    v_permlane16_swap_b32 v112, v114
    v_permlane16_swap_b32 v113, v115
    v_cvt_pk_bf16_f32 v116, v172, v173
    v_cvt_pk_bf16_f32 v117, v174, v175
    v_cvt_pk_bf16_f32 v118, v188, v189
    v_cvt_pk_bf16_f32 v119, v190, v191
    s_nop 0
    v_permlane16_swap_b32 v116, v118
    v_permlane16_swap_b32 v117, v119
    v_cvt_pk_bf16_f32 v120, v204, v205
    v_cvt_pk_bf16_f32 v121, v206, v207
    v_cvt_pk_bf16_f32 v122, v220, v221
    v_cvt_pk_bf16_f32 v123, v222, v223
    s_nop 0
    v_permlane16_swap_b32 v120, v122
    v_permlane16_swap_b32 v121, v123
    v_cvt_pk_bf16_f32 v124, v236, v237
    v_cvt_pk_bf16_f32 v125, v238, v239
    v_cvt_pk_bf16_f32 v126, v252, v253
    v_cvt_pk_bf16_f32 v127, v254, v255
    s_nop 0
    v_permlane16_swap_b32 v124, v126
    v_permlane16_swap_b32 v125, v127
    s_mul_i32 s70, s60, 0x4200
    v_and_b32 v11, 15, v0
    v_add_u32 v11, 4, v11
    v_lshrrev_b32 v11, 3, v11
    v_and_b32 v11, 1, v11
    v_and_b32 v10, 15, v0
    v_and_b32 v9, 15, v0
    v_add_u32 v9, 4, v9
    v_lshrrev_b32 v9, 3, v9
    v_and_b32 v9, 1, v9
    v_mul_u32_u24 v9, 4, v9
    v_sub_u32 v10, v10, v9
    v_mul_u32_u24 v11, v11, v10
    v_and_b32 v10, 15, v0
    v_add_u32 v10, 4, v10
    v_lshrrev_b32 v10, 3, v10
    v_and_b32 v10, 1, v10
    v_xor_b32 v10, 1, v10
    v_and_b32 v9, 15, v0
    v_and_b32 v9, 3, v9
    v_and_b32 v8, 15, v0
    v_lshrrev_b32 v8, 3, v8
    v_lshlrev_b32 v8, 2, v8
    v_add_u32 v9, v9, v8
    v_mul_u32_u24 v10, v10, v9
    v_add_u32 v11, v11, v10
    v_mul_u32_u24 v11, 0x400, v11
    v_and_b32 v10, 15, v0
    v_add_u32 v10, 4, v10
    v_lshrrev_b32 v10, 3, v10
    v_and_b32 v10, 1, v10
    v_and_b32 v9, 15, v0
    v_and_b32 v8, 15, v0
    v_add_u32 v8, 4, v8
    v_lshrrev_b32 v8, 3, v8
    v_and_b32 v8, 1, v8
    v_mul_u32_u24 v8, 4, v8
    v_sub_u32 v9, v9, v8
    v_mul_u32_u24 v10, v10, v9
    v_and_b32 v9, 15, v0
    v_add_u32 v9, 4, v9
    v_lshrrev_b32 v9, 3, v9
    v_and_b32 v9, 1, v9
    v_xor_b32 v9, 1, v9
    v_and_b32 v8, 15, v0
    v_and_b32 v8, 3, v8
    v_and_b32 v7, 15, v0
    v_lshrrev_b32 v7, 3, v7
    v_lshlrev_b32 v7, 2, v7
    v_add_u32 v8, v8, v7
    v_mul_u32_u24 v9, v9, v8
    v_add_u32 v10, v10, v9
    v_and_b32 v10, 1, v10
    v_mul_u32_u24 v10, 16, v10
    v_add_u32 v11, v11, v10
    v_and_b32 v10, 15, v0
    v_add_u32 v10, 4, v10
    v_lshrrev_b32 v10, 3, v10
    v_and_b32 v10, 1, v10
    v_and_b32 v9, 15, v0
    v_and_b32 v8, 15, v0
    v_add_u32 v8, 4, v8
    v_lshrrev_b32 v8, 3, v8
    v_and_b32 v8, 1, v8
    v_mul_u32_u24 v8, 4, v8
    v_sub_u32 v9, v9, v8
    v_mul_u32_u24 v10, v10, v9
    v_and_b32 v9, 15, v0
    v_add_u32 v9, 4, v9
    v_lshrrev_b32 v9, 3, v9
    v_and_b32 v9, 1, v9
    v_xor_b32 v9, 1, v9
    v_and_b32 v8, 15, v0
    v_and_b32 v8, 3, v8
    v_and_b32 v7, 15, v0
    v_lshrrev_b32 v7, 3, v7
    v_lshlrev_b32 v7, 2, v7
    v_add_u32 v8, v8, v7
    v_mul_u32_u24 v9, v9, v8
    v_add_u32 v10, v10, v9
    v_lshrrev_b32 v10, 1, v10
    v_mul_u32_u24 v10, 64, v10
    v_add_u32 v11, v11, v10
    v_and_b32 v10, 15, v0
    v_add_u32 v10, 4, v10
    v_lshrrev_b32 v10, 3, v10
    v_and_b32 v10, 1, v10
    v_mul_u32_u24 v10, 0x100, v10
    v_add_u32 v11, v11, v10
    v_lshrrev_b32 v10, 4, v0
    v_and_b32 v10, 3, v10
    v_and_b32 v10, 1, v10
    v_lshlrev_b32 v10, 1, v10
    v_lshrrev_b32 v9, 4, v0
    v_and_b32 v9, 3, v9
    v_lshrrev_b32 v9, 1, v9
    v_or_b32 v10, v10, v9
    v_mul_u32_u24 v10, 16, v10
    v_add_u32 v11, v11, v10
    v_add_u32 v1, s70, v11
    v_lshrrev_b32 v11, 2, v0
    v_and_b32 v11, 3, v11
    v_lshrrev_b32 v10, 4, v0
    v_and_b32 v10, 3, v10
    v_and_b32 v10, 1, v10
    v_lshlrev_b32 v10, 2, v10
    v_add_u32 v11, v11, v10
    v_mul_u32_u24 v11, 0x420, v11
    v_lshrrev_b32 v10, 4, v0
    v_and_b32 v10, 3, v10
    v_lshrrev_b32 v10, 1, v10
    v_mul_u32_u24 v10, 0x100, v10
    v_add_u32 v11, v11, v10
    v_and_b32 v10, 3, v0
    v_mul_u32_u24 v10, 8, v10
    v_add_u32 v11, v11, v10
    v_add_u32 v2, s70, v11
    v_mov_b32 v16, 0x7f800000
    v_mov_b32 v12, 0
    v_mov_b32 v17, 0x7f800000
    v_mov_b32 v13, 0
    v_mov_b32 v18, 0x7f800000
    v_mov_b32 v14, 0
    v_mov_b32 v19, 0x7f800000
    v_mov_b32 v15, 0
    s_mov_b32 s67, 0
    s_mov_b32 s68, 1
    s_mov_b32 s72, 0x6000
    s_mov_b32 s73, 0
    s_waitcnt vmcnt(0)
    s_barrier
    s_mov_b32 s70, 0x2000
    s_add_u32 m0, s80, 0x8400
    s_nop 0
    buffer_load_dwordx4 v3, s[12:15], s70 offen nt lds
    s_add_u32 m0, s80, 0x8710
    s_nop 0
    buffer_load_dwordx4 v3, s[12:15], s70 offen offset:256 nt lds
    s_add_u32 m0, s80, 0xa500
    s_nop 0
    buffer_load_dwordx4 v4, s[16:19], s70 offen nt lds
    s_add_u32 m0, s80, 0xa820
    s_nop 0
    buffer_load_dwordx4 v4, s[16:19], s70 offen offset:256 nt lds
    s_mov_b32 s70, 0x4000
    s_add_u32 m0, s80, 0x10800
    s_nop 0
    buffer_load_dwordx4 v3, s[12:15], s70 offen nt lds
    s_add_u32 m0, s80, 0x10b10
    s_nop 0
    buffer_load_dwordx4 v3, s[12:15], s70 offen offset:256 nt lds
    s_add_u32 m0, s80, 0x12900
    s_nop 0
    buffer_load_dwordx4 v4, s[16:19], s70 offen nt lds
    s_add_u32 m0, s80, 0x12c20
    s_nop 0
    buffer_load_dwordx4 v4, s[16:19], s70 offen offset:256 nt lds
chunk_top_4a:
    s_waitcnt vmcnt(8)
    s_barrier
    s_cmp_lg_u32 s68, 0
    s_cbranch_scc1 slow_qk_4a
    ds_read_b128 v[20:23], v1 offset:0
    ds_read_b128 v[24:27], v1 offset:64
    ds_read_b128 v[28:31], v1 offset:128
    s_waitcnt lgkmcnt(2)
    v_mfma_f32_16x16x32_bf16 v[32:35], v[20:23], v[64:67], 0
    v_mfma_f32_16x16x32_bf16 v[40:43], v[20:23], v[80:83], 0
    v_mfma_f32_16x16x32_bf16 v[48:51], v[20:23], v[96:99], 0
    v_mfma_f32_16x16x32_bf16 v[56:59], v[20:23], v[112:115], 0
    ds_read_b128 v[20:23], v1 offset:192
    s_waitcnt lgkmcnt(2)
    v_mfma_f32_16x16x32_bf16 v[32:35], v[24:27], v[68:71], v[32:35]
    v_mfma_f32_16x16x32_bf16 v[40:43], v[24:27], v[84:87], v[40:43]
    v_mfma_f32_16x16x32_bf16 v[48:51], v[24:27], v[100:103], v[48:51]
    v_mfma_f32_16x16x32_bf16 v[56:59], v[24:27], v[116:119], v[56:59]
    ds_read_b128 v[24:27], v1 offset:512
    s_waitcnt lgkmcnt(2)
    v_mfma_f32_16x16x32_bf16 v[32:35], v[28:31], v[72:75], v[32:35]
    v_mfma_f32_16x16x32_bf16 v[40:43], v[28:31], v[88:91], v[40:43]
    v_mfma_f32_16x16x32_bf16 v[48:51], v[28:31], v[104:107], v[48:51]
    v_mfma_f32_16x16x32_bf16 v[56:59], v[28:31], v[120:123], v[56:59]
    ds_read_b128 v[28:31], v1 offset:576
    s_waitcnt lgkmcnt(2)
    v_mfma_f32_16x16x32_bf16 v[32:35], v[20:23], v[76:79], v[32:35]
    v_mfma_f32_16x16x32_bf16 v[40:43], v[20:23], v[92:95], v[40:43]
    v_mfma_f32_16x16x32_bf16 v[48:51], v[20:23], v[108:111], v[48:51]
    v_mfma_f32_16x16x32_bf16 v[56:59], v[20:23], v[124:127], v[56:59]
    ds_read_b128 v[20:23], v1 offset:640
    s_waitcnt lgkmcnt(2)
    v_mfma_f32_16x16x32_bf16 v[36:39], v[24:27], v[64:67], 0
    s_nop 1
    v_fma_f32 v32, v32, s64, v16
    v_fma_f32 v33, v33, s64, v16
    v_fma_f32 v34, v34, s64, v16
    v_fma_f32 v35, v35, s64, v16
    v_mfma_f32_16x16x32_bf16 v[44:47], v[24:27], v[80:83], 0
    v_exp_f32 v32, v32
    v_exp_f32 v33, v33
    v_exp_f32 v34, v34
    v_exp_f32 v35, v35
    v_mfma_f32_16x16x32_bf16 v[52:55], v[24:27], v[96:99], 0
    v_add_f32 v7, v32, v33
    v_add_f32 v11, v34, v35
    v_add_f32 v7, v7, v11
    v_cvt_pk_bf16_f32 v32, v32, v33
    v_mfma_f32_16x16x32_bf16 v[60:63], v[24:27], v[112:115], 0
    v_cvt_pk_bf16_f32 v33, v34, v35
    v_fma_f32 v40, v40, s64, v17
    v_fma_f32 v41, v41, s64, v17
    v_fma_f32 v42, v42, s64, v17
    ds_read_b128 v[24:27], v1 offset:704
    s_waitcnt lgkmcnt(2)
    v_mfma_f32_16x16x32_bf16 v[36:39], v[28:31], v[68:71], v[36:39]
    v_fma_f32 v43, v43, s64, v17
    v_exp_f32 v40, v40
    v_exp_f32 v41, v41
    v_exp_f32 v42, v42
    v_mfma_f32_16x16x32_bf16 v[44:47], v[28:31], v[84:87], v[44:47]
    v_exp_f32 v43, v43
    v_add_f32 v8, v40, v41
    v_add_f32 v11, v42, v43
    v_add_f32 v8, v8, v11
    v_mfma_f32_16x16x32_bf16 v[52:55], v[28:31], v[100:103], v[52:55]
    v_cvt_pk_bf16_f32 v40, v40, v41
    v_cvt_pk_bf16_f32 v41, v42, v43
    v_fma_f32 v48, v48, s64, v18
    v_fma_f32 v49, v49, s64, v18
    v_mfma_f32_16x16x32_bf16 v[60:63], v[28:31], v[116:119], v[60:63]
    v_fma_f32 v50, v50, s64, v18
    v_fma_f32 v51, v51, s64, v18
    v_exp_f32 v48, v48
    v_exp_f32 v49, v49
    s_waitcnt lgkmcnt(1)
    v_mfma_f32_16x16x32_bf16 v[36:39], v[20:23], v[72:75], v[36:39]
    v_exp_f32 v50, v50
    v_exp_f32 v51, v51
    v_add_f32 v9, v48, v49
    v_add_f32 v11, v50, v51
    v_mfma_f32_16x16x32_bf16 v[44:47], v[20:23], v[88:91], v[44:47]
    v_add_f32 v9, v9, v11
    v_cvt_pk_bf16_f32 v48, v48, v49
    v_cvt_pk_bf16_f32 v49, v50, v51
    v_fma_f32 v56, v56, s64, v19
    v_mfma_f32_16x16x32_bf16 v[52:55], v[20:23], v[104:107], v[52:55]
    v_fma_f32 v57, v57, s64, v19
    v_fma_f32 v58, v58, s64, v19
    v_fma_f32 v59, v59, s64, v19
    v_exp_f32 v56, v56
    v_mfma_f32_16x16x32_bf16 v[60:63], v[20:23], v[120:123], v[60:63]
    v_exp_f32 v57, v57
    v_exp_f32 v58, v58
    v_exp_f32 v59, v59
    v_add_f32 v10, v56, v57
    s_waitcnt lgkmcnt(0)
    v_mfma_f32_16x16x32_bf16 v[36:39], v[24:27], v[76:79], v[36:39]
    v_add_f32 v11, v58, v59
    v_add_f32 v10, v10, v11
    v_cvt_pk_bf16_f32 v56, v56, v57
    v_cvt_pk_bf16_f32 v57, v58, v59
    v_mfma_f32_16x16x32_bf16 v[44:47], v[24:27], v[92:95], v[44:47]
    v_mfma_f32_16x16x32_bf16 v[52:55], v[24:27], v[108:111], v[52:55]
    v_mfma_f32_16x16x32_bf16 v[60:63], v[24:27], v[124:127], v[60:63]
tp1_4a:
    s_nop 3
    v_fma_f32 v36, v36, s64, v16
    v_fma_f32 v37, v37, s64, v16
    v_fma_f32 v38, v38, s64, v16
    v_fma_f32 v39, v39, s64, v16
    v_exp_f32 v36, v36
    v_exp_f32 v37, v37
    v_exp_f32 v38, v38
    v_exp_f32 v39, v39
    v_add_f32 v7, v7, v36
    v_add_f32 v11, v37, v38
    v_add_f32 v7, v7, v39
    v_add_f32 v7, v7, v11
    v_fma_f32 v44, v44, s64, v17
    v_fma_f32 v45, v45, s64, v17
    v_fma_f32 v46, v46, s64, v17
    v_fma_f32 v47, v47, s64, v17
    v_exp_f32 v44, v44
    v_exp_f32 v45, v45
    v_exp_f32 v46, v46
    v_exp_f32 v47, v47
    v_add_f32 v8, v8, v44
    v_add_f32 v11, v45, v46
    v_add_f32 v8, v8, v47
    v_add_f32 v8, v8, v11
    v_fma_f32 v52, v52, s64, v18
    v_fma_f32 v53, v53, s64, v18
    v_fma_f32 v54, v54, s64, v18
    v_fma_f32 v55, v55, s64, v18
    v_exp_f32 v52, v52
    v_exp_f32 v53, v53
    v_exp_f32 v54, v54
    v_exp_f32 v55, v55
    v_add_f32 v9, v9, v52
    v_add_f32 v11, v53, v54
    v_add_f32 v9, v9, v55
    v_add_f32 v9, v9, v11
    v_fma_f32 v60, v60, s64, v19
    v_fma_f32 v61, v61, s64, v19
    v_fma_f32 v62, v62, s64, v19
    v_fma_f32 v63, v63, s64, v19
    v_exp_f32 v60, v60
    v_exp_f32 v61, v61
    v_exp_f32 v62, v62
    v_exp_f32 v63, v63
    v_add_f32 v10, v10, v60
    v_add_f32 v11, v61, v62
    v_add_f32 v10, v10, v63
    v_add_f32 v10, v10, v11
    v_max3_f32 v11, v7, v8, v9
    v_max_f32 v11, v11, v10
    v_cmp_nge_f32 vcc, s66, v11
    s_cbranch_vccnz redo_4a
cont_4a:
    s_mov_b32 s68, 0
    ds_read_b64_tr_b16 v[20:21], v2 offset:8448
    ds_read_b64_tr_b16 v[22:23], v2 offset:8960
    ds_read_b64_tr_b16 v[24:25], v2 offset:8480
    ds_read_b64_tr_b16 v[26:27], v2 offset:8992
    ds_read_b64_tr_b16 v[28:29], v2 offset:8512
    ds_read_b64_tr_b16 v[30:31], v2 offset:9024
    v_cvt_pk_bf16_f32 v34, v36, v37
    v_cvt_pk_bf16_f32 v35, v38, v39
    v_cvt_pk_bf16_f32 v42, v44, v45
    v_cvt_pk_bf16_f32 v43, v46, v47
    v_cvt_pk_bf16_f32 v50, v52, v53
    v_cvt_pk_bf16_f32 v51, v54, v55
    v_cvt_pk_bf16_f32 v58, v60, v61
    v_cvt_pk_bf16_f32 v59, v62, v63
    s_waitcnt lgkmcnt(4)
    v_mfma_f32_16x16x32_bf16 v[128:131], v[20:23], v[32:35], v[128:131]
    v_mfma_f32_16x16x32_bf16 v[132:135], v[20:23], v[40:43], v[132:135]
    v_mfma_f32_16x16x32_bf16 v[136:139], v[20:23], v[48:51], v[136:139]
    v_mfma_f32_16x16x32_bf16 v[140:143], v[20:23], v[56:59], v[140:143]
    ds_read_b64_tr_b16 v[20:21], v2 offset:8544
    ds_read_b64_tr_b16 v[22:23], v2 offset:9056
    v_add_f32 v12, v12, v7
    v_add_f32 v13, v13, v8
    v_add_f32 v14, v14, v9
    v_add_f32 v15, v15, v10
    s_add_u32 s69, s67, 3
    s_and_b32 s69, s69, 3
    s_mul_i32 s74, s69, 0x8400
    s_add_u32 s74, s74, s80
    s_add_u32 s67, s67, 1
    s_and_b32 s69, s67, 3
    s_mul_i32 s69, s69, 0x8400
    s_sub_u32 s75, s69, s73
    s_mov_b32 s73, s69
    s_waitcnt lgkmcnt(4)
    v_mfma_f32_16x16x32_bf16 v[144:147], v[24:27], v[32:35], v[144:147]
    v_mfma_f32_16x16x32_bf16 v[148:151], v[24:27], v[40:43], v[148:151]
    v_mfma_f32_16x16x32_bf16 v[152:155], v[24:27], v[48:51], v[152:155]
    v_mfma_f32_16x16x32_bf16 v[156:159], v[24:27], v[56:59], v[156:159]
    ds_read_b64_tr_b16 v[24:25], v2 offset:8576
    ds_read_b64_tr_b16 v[26:27], v2 offset:9088
    s_add_u32 m0, s74, 0
    s_nop 0
    buffer_load_dwordx4 v3, s[12:15], s72 offen nt lds
    s_waitcnt lgkmcnt(4)
    v_mfma_f32_16x16x32_bf16 v[160:163], v[28:31], v[32:35], v[160:163]
    v_mfma_f32_16x16x32_bf16 v[164:167], v[28:31], v[40:43], v[164:167]
    v_mfma_f32_16x16x32_bf16 v[168:171], v[28:31], v[48:51], v[168:171]
    v_mfma_f32_16x16x32_bf16 v[172:175], v[28:31], v[56:59], v[172:175]
    ds_read_b64_tr_b16 v[28:29], v2 offset:8608
    ds_read_b64_tr_b16 v[30:31], v2 offset:9120
    s_add_u32 m0, s74, 0x310
    s_nop 0
    buffer_load_dwordx4 v3, s[12:15], s72 offen offset:256 nt lds
    s_waitcnt lgkmcnt(4)
    v_mfma_f32_16x16x32_bf16 v[176:179], v[20:23], v[32:35], v[176:179]
    v_mfma_f32_16x16x32_bf16 v[180:183], v[20:23], v[40:43], v[180:183]
    v_mfma_f32_16x16x32_bf16 v[184:187], v[20:23], v[48:51], v[184:187]
    v_mfma_f32_16x16x32_bf16 v[188:191], v[20:23], v[56:59], v[188:191]
    ds_read_b64_tr_b16 v[20:21], v2 offset:8640
    ds_read_b64_tr_b16 v[22:23], v2 offset:9152
    s_add_u32 m0, s74, 0x2100
    s_nop 0
    buffer_load_dwordx4 v4, s[16:19], s72 offen nt lds
    s_waitcnt lgkmcnt(4)
    v_mfma_f32_16x16x32_bf16 v[192:195], v[24:27], v[32:35], v[192:195]
    v_mfma_f32_16x16x32_bf16 v[196:199], v[24:27], v[40:43], v[196:199]
    v_mfma_f32_16x16x32_bf16 v[200:203], v[24:27], v[48:51], v[200:203]
    v_mfma_f32_16x16x32_bf16 v[204:207], v[24:27], v[56:59], v[204:207]
    ds_read_b64_tr_b16 v[24:25], v2 offset:8672
    ds_read_b64_tr_b16 v[26:27], v2 offset:9184
    s_add_u32 m0, s74, 0x2420
    s_nop 0
    buffer_load_dwordx4 v4, s[16:19], s72 offen offset:256 nt lds
    s_waitcnt lgkmcnt(4)
    v_mfma_f32_16x16x32_bf16 v[208:211], v[28:31], v[32:35], v[208:211]
    v_mfma_f32_16x16x32_bf16 v[212:215], v[28:31], v[40:43], v[212:215]
    v_mfma_f32_16x16x32_bf16 v[216:219], v[28:31], v[48:51], v[216:219]
    v_mfma_f32_16x16x32_bf16 v[220:223], v[28:31], v[56:59], v[220:223]
    s_add_u32 s72, s72, 0x2000
    v_add_u32 v1, s75, v1
    v_add_u32 v2, s75, v2
    s_waitcnt lgkmcnt(2)
    v_mfma_f32_16x16x32_bf16 v[224:227], v[20:23], v[32:35], v[224:227]
    v_mfma_f32_16x16x32_bf16 v[228:231], v[20:23], v[40:43], v[228:231]
    v_mfma_f32_16x16x32_bf16 v[232:235], v[20:23], v[48:51], v[232:235]
    v_mfma_f32_16x16x32_bf16 v[236:239], v[20:23], v[56:59], v[236:239]
    s_waitcnt lgkmcnt(0)
    v_mfma_f32_16x16x32_bf16 v[240:243], v[24:27], v[32:35], v[240:243]
    v_mfma_f32_16x16x32_bf16 v[244:247], v[24:27], v[40:43], v[244:247]
    v_mfma_f32_16x16x32_bf16 v[248:251], v[24:27], v[48:51], v[248:251]
    v_mfma_f32_16x16x32_bf16 v[252:255], v[24:27], v[56:59], v[252:255]
    s_cmp_lt_u32 s67, 16
    s_cbranch_scc1 chunk_top_4a
    v_lshlrev_b32 v7, 4, v0
    s_lshl_b32 s69, s63, 12
    v_add_u32 v7, s69, v7
    v_mov_b32 v8, v12
    s_nop 1
    v_permlane32_swap_b32 v12, v8
    v_add_f32 v12, v12, v8
    v_mov_b32 v8, v12
    s_nop 1
    v_permlane16_swap_b32 v12, v8
    v_add_f32 v12, v12, v8
    v_rcp_f32 v12, v12
    v_mov_b32 v8, v13
    s_nop 1
    v_permlane32_swap_b32 v13, v8
    v_add_f32 v13, v13, v8
    v_mov_b32 v8, v13
    s_nop 1
    v_permlane16_swap_b32 v13, v8
    v_add_f32 v13, v13, v8
    v_rcp_f32 v13, v13
    v_mov_b32 v8, v14
    s_nop 1
    v_permlane32_swap_b32 v14, v8
    v_add_f32 v14, v14, v8
    v_mov_b32 v8, v14
    s_nop 1
    v_permlane16_swap_b32 v14, v8
    v_add_f32 v14, v14, v8
    v_rcp_f32 v14, v14
    v_mov_b32 v8, v15
    s_nop 1
    v_permlane32_swap_b32 v15, v8
    v_add_f32 v15, v15, v8
    v_mov_b32 v8, v15
    s_nop 1
    v_permlane16_swap_b32 v15, v8
    v_add_f32 v15, v15, v8
    v_rcp_f32 v15, v15
    s_mov_b32 s69, 0
    v_mul_f32 v128, v128, v12
    v_mul_f32 v144, v144, v12
    v_mul_f32 v129, v129, v12
    v_mul_f32 v145, v145, v12
    v_mul_f32 v130, v130, v12
    v_mul_f32 v146, v146, v12
    v_mul_f32 v131, v131, v12
    v_mul_f32 v147, v147, v12
    v_cvt_pk_bf16_f32 v64, v128, v129
    v_cvt_pk_bf16_f32 v65, v130, v131
    v_cvt_pk_bf16_f32 v66, v144, v145
    v_cvt_pk_bf16_f32 v67, v146, v147
    s_nop 0
    v_permlane16_swap_b32 v64, v66
    v_permlane16_swap_b32 v65, v67
    buffer_store_dwordx4 v[64:67], v7, s[20:23], s69 offen nt
    v_mul_f32 v160, v160, v12
    v_mul_f32 v176, v176, v12
    v_mul_f32 v161, v161, v12
    v_mul_f32 v177, v177, v12
    v_mul_f32 v162, v162, v12
    v_mul_f32 v178, v178, v12
    v_mul_f32 v163, v163, v12
    v_mul_f32 v179, v179, v12
    v_cvt_pk_bf16_f32 v68, v160, v161
    v_cvt_pk_bf16_f32 v69, v162, v163
    v_cvt_pk_bf16_f32 v70, v176, v177
    v_cvt_pk_bf16_f32 v71, v178, v179
    s_nop 0
    v_permlane16_swap_b32 v68, v70
    v_permlane16_swap_b32 v69, v71
    buffer_store_dwordx4 v[68:71], v7, s[20:23], s69 offen offset:1024 nt
    v_mul_f32 v192, v192, v12
    v_mul_f32 v208, v208, v12
    v_mul_f32 v193, v193, v12
    v_mul_f32 v209, v209, v12
    v_mul_f32 v194, v194, v12
    v_mul_f32 v210, v210, v12
    v_mul_f32 v195, v195, v12
    v_mul_f32 v211, v211, v12
    v_cvt_pk_bf16_f32 v72, v192, v193
    v_cvt_pk_bf16_f32 v73, v194, v195
    v_cvt_pk_bf16_f32 v74, v208, v209
    v_cvt_pk_bf16_f32 v75, v210, v211
    s_nop 0
    v_permlane16_swap_b32 v72, v74
    v_permlane16_swap_b32 v73, v75
    buffer_store_dwordx4 v[72:75], v7, s[20:23], s69 offen offset:2048 nt
    v_mul_f32 v224, v224, v12
    v_mul_f32 v240, v240, v12
    v_mul_f32 v225, v225, v12
    v_mul_f32 v241, v241, v12
    v_mul_f32 v226, v226, v12
    v_mul_f32 v242, v242, v12
    v_mul_f32 v227, v227, v12
    v_mul_f32 v243, v243, v12
    v_cvt_pk_bf16_f32 v76, v224, v225
    v_cvt_pk_bf16_f32 v77, v226, v227
    v_cvt_pk_bf16_f32 v78, v240, v241
    v_cvt_pk_bf16_f32 v79, v242, v243
    s_nop 0
    v_permlane16_swap_b32 v76, v78
    v_permlane16_swap_b32 v77, v79
    buffer_store_dwordx4 v[76:79], v7, s[20:23], s69 offen offset:3072 nt
    s_mov_b32 s69, 0x1000
    v_mul_f32 v132, v132, v13
    v_mul_f32 v148, v148, v13
    v_mul_f32 v133, v133, v13
    v_mul_f32 v149, v149, v13
    v_mul_f32 v134, v134, v13
    v_mul_f32 v150, v150, v13
    v_mul_f32 v135, v135, v13
    v_mul_f32 v151, v151, v13
    v_cvt_pk_bf16_f32 v80, v132, v133
    v_cvt_pk_bf16_f32 v81, v134, v135
    v_cvt_pk_bf16_f32 v82, v148, v149
    v_cvt_pk_bf16_f32 v83, v150, v151
    s_nop 0
    v_permlane16_swap_b32 v80, v82
    v_permlane16_swap_b32 v81, v83
    buffer_store_dwordx4 v[80:83], v7, s[20:23], s69 offen nt
    v_mul_f32 v164, v164, v13
    v_mul_f32 v180, v180, v13
    v_mul_f32 v165, v165, v13
    v_mul_f32 v181, v181, v13
    v_mul_f32 v166, v166, v13
    v_mul_f32 v182, v182, v13
    v_mul_f32 v167, v167, v13
    v_mul_f32 v183, v183, v13
    v_cvt_pk_bf16_f32 v84, v164, v165
    v_cvt_pk_bf16_f32 v85, v166, v167
    v_cvt_pk_bf16_f32 v86, v180, v181
    v_cvt_pk_bf16_f32 v87, v182, v183
    s_nop 0
    v_permlane16_swap_b32 v84, v86
    v_permlane16_swap_b32 v85, v87
    buffer_store_dwordx4 v[84:87], v7, s[20:23], s69 offen offset:1024 nt
    v_mul_f32 v196, v196, v13
    v_mul_f32 v212, v212, v13
    v_mul_f32 v197, v197, v13
    v_mul_f32 v213, v213, v13
    v_mul_f32 v198, v198, v13
    v_mul_f32 v214, v214, v13
    v_mul_f32 v199, v199, v13
    v_mul_f32 v215, v215, v13
    v_cvt_pk_bf16_f32 v88, v196, v197
    v_cvt_pk_bf16_f32 v89, v198, v199
    v_cvt_pk_bf16_f32 v90, v212, v213
    v_cvt_pk_bf16_f32 v91, v214, v215
    s_nop 0
    v_permlane16_swap_b32 v88, v90
    v_permlane16_swap_b32 v89, v91
    buffer_store_dwordx4 v[88:91], v7, s[20:23], s69 offen offset:2048 nt
    v_mul_f32 v228, v228, v13
    v_mul_f32 v244, v244, v13
    v_mul_f32 v229, v229, v13
    v_mul_f32 v245, v245, v13
    v_mul_f32 v230, v230, v13
    v_mul_f32 v246, v246, v13
    v_mul_f32 v231, v231, v13
    v_mul_f32 v247, v247, v13
    v_cvt_pk_bf16_f32 v92, v228, v229
    v_cvt_pk_bf16_f32 v93, v230, v231
    v_cvt_pk_bf16_f32 v94, v244, v245
    v_cvt_pk_bf16_f32 v95, v246, v247
    s_nop 0
    v_permlane16_swap_b32 v92, v94
    v_permlane16_swap_b32 v93, v95
    buffer_store_dwordx4 v[92:95], v7, s[20:23], s69 offen offset:3072 nt
    s_mov_b32 s69, 0x2000
    v_mul_f32 v136, v136, v14
    v_mul_f32 v152, v152, v14
    v_mul_f32 v137, v137, v14
    v_mul_f32 v153, v153, v14
    v_mul_f32 v138, v138, v14
    v_mul_f32 v154, v154, v14
    v_mul_f32 v139, v139, v14
    v_mul_f32 v155, v155, v14
    v_cvt_pk_bf16_f32 v96, v136, v137
    v_cvt_pk_bf16_f32 v97, v138, v139
    v_cvt_pk_bf16_f32 v98, v152, v153
    v_cvt_pk_bf16_f32 v99, v154, v155
    s_nop 0
    v_permlane16_swap_b32 v96, v98
    v_permlane16_swap_b32 v97, v99
    buffer_store_dwordx4 v[96:99], v7, s[20:23], s69 offen nt
    v_mul_f32 v168, v168, v14
    v_mul_f32 v184, v184, v14
    v_mul_f32 v169, v169, v14
    v_mul_f32 v185, v185, v14
    v_mul_f32 v170, v170, v14
    v_mul_f32 v186, v186, v14
    v_mul_f32 v171, v171, v14
    v_mul_f32 v187, v187, v14
    v_cvt_pk_bf16_f32 v100, v168, v169
    v_cvt_pk_bf16_f32 v101, v170, v171
    v_cvt_pk_bf16_f32 v102, v184, v185
    v_cvt_pk_bf16_f32 v103, v186, v187
    s_nop 0
    v_permlane16_swap_b32 v100, v102
    v_permlane16_swap_b32 v101, v103
    buffer_store_dwordx4 v[100:103], v7, s[20:23], s69 offen offset:1024 nt
    v_mul_f32 v200, v200, v14
    v_mul_f32 v216, v216, v14
    v_mul_f32 v201, v201, v14
    v_mul_f32 v217, v217, v14
    v_mul_f32 v202, v202, v14
    v_mul_f32 v218, v218, v14
    v_mul_f32 v203, v203, v14
    v_mul_f32 v219, v219, v14
    v_cvt_pk_bf16_f32 v104, v200, v201
    v_cvt_pk_bf16_f32 v105, v202, v203
    v_cvt_pk_bf16_f32 v106, v216, v217
    v_cvt_pk_bf16_f32 v107, v218, v219
    s_nop 0
    v_permlane16_swap_b32 v104, v106
    v_permlane16_swap_b32 v105, v107
    buffer_store_dwordx4 v[104:107], v7, s[20:23], s69 offen offset:2048 nt
    v_mul_f32 v232, v232, v14
    v_mul_f32 v248, v248, v14
    v_mul_f32 v233, v233, v14
    v_mul_f32 v249, v249, v14
    v_mul_f32 v234, v234, v14
    v_mul_f32 v250, v250, v14
    v_mul_f32 v235, v235, v14
    v_mul_f32 v251, v251, v14
    v_cvt_pk_bf16_f32 v108, v232, v233
    v_cvt_pk_bf16_f32 v109, v234, v235
    v_cvt_pk_bf16_f32 v110, v248, v249
    v_cvt_pk_bf16_f32 v111, v250, v251
    s_nop 0
    v_permlane16_swap_b32 v108, v110
    v_permlane16_swap_b32 v109, v111
    buffer_store_dwordx4 v[108:111], v7, s[20:23], s69 offen offset:3072 nt
    s_mov_b32 s69, 0x3000
    v_mul_f32 v140, v140, v15
    v_mul_f32 v156, v156, v15
    v_mul_f32 v141, v141, v15
    v_mul_f32 v157, v157, v15
    v_mul_f32 v142, v142, v15
    v_mul_f32 v158, v158, v15
    v_mul_f32 v143, v143, v15
    v_mul_f32 v159, v159, v15
    v_cvt_pk_bf16_f32 v112, v140, v141
    v_cvt_pk_bf16_f32 v113, v142, v143
    v_cvt_pk_bf16_f32 v114, v156, v157
    v_cvt_pk_bf16_f32 v115, v158, v159
    s_nop 0
    v_permlane16_swap_b32 v112, v114
    v_permlane16_swap_b32 v113, v115
    buffer_store_dwordx4 v[112:115], v7, s[20:23], s69 offen nt
    v_mul_f32 v172, v172, v15
    v_mul_f32 v188, v188, v15
    v_mul_f32 v173, v173, v15
    v_mul_f32 v189, v189, v15
    v_mul_f32 v174, v174, v15
    v_mul_f32 v190, v190, v15
    v_mul_f32 v175, v175, v15
    v_mul_f32 v191, v191, v15
    v_cvt_pk_bf16_f32 v116, v172, v173
    v_cvt_pk_bf16_f32 v117, v174, v175
    v_cvt_pk_bf16_f32 v118, v188, v189
    v_cvt_pk_bf16_f32 v119, v190, v191
    s_nop 0
    v_permlane16_swap_b32 v116, v118
    v_permlane16_swap_b32 v117, v119
    buffer_store_dwordx4 v[116:119], v7, s[20:23], s69 offen offset:1024 nt
    v_mul_f32 v204, v204, v15
    v_mul_f32 v220, v220, v15
    v_mul_f32 v205, v205, v15
    v_mul_f32 v221, v221, v15
    v_mul_f32 v206, v206, v15
    v_mul_f32 v222, v222, v15
    v_mul_f32 v207, v207, v15
    v_mul_f32 v223, v223, v15
    v_cvt_pk_bf16_f32 v120, v204, v205
    v_cvt_pk_bf16_f32 v121, v206, v207
    v_cvt_pk_bf16_f32 v122, v220, v221
    v_cvt_pk_bf16_f32 v123, v222, v223
    s_nop 0
    v_permlane16_swap_b32 v120, v122
    v_permlane16_swap_b32 v121, v123
    buffer_store_dwordx4 v[120:123], v7, s[20:23], s69 offen offset:2048 nt
    v_mul_f32 v236, v236, v15
    v_mul_f32 v252, v252, v15
    v_mul_f32 v237, v237, v15
    v_mul_f32 v253, v253, v15
    v_mul_f32 v238, v238, v15
    v_mul_f32 v254, v254, v15
    v_mul_f32 v239, v239, v15
    v_mul_f32 v255, v255, v15
    v_cvt_pk_bf16_f32 v124, v236, v237
    v_cvt_pk_bf16_f32 v125, v238, v239
    v_cvt_pk_bf16_f32 v126, v252, v253
    v_cvt_pk_bf16_f32 v127, v254, v255
    s_nop 0
    v_permlane16_swap_b32 v124, v126
    v_permlane16_swap_b32 v125, v127
    buffer_store_dwordx4 v[124:127], v7, s[20:23], s69 offen offset:3072 nt
    s_endpgm
redo_4a:
    s_cmp_eq_u32 s68, 2
    s_cbranch_scc1 cont_4a
slow_qk_4a:
    ds_read_b128 v[20:23], v1 offset:0
    ds_read_b128 v[24:27], v1 offset:64
    ds_read_b128 v[28:31], v1 offset:128
    s_waitcnt lgkmcnt(2)
    v_mfma_f32_16x16x32_bf16 v[32:35], v[20:23], v[64:67], 0
    v_mfma_f32_16x16x32_bf16 v[40:43], v[20:23], v[80:83], 0
    v_mfma_f32_16x16x32_bf16 v[48:51], v[20:23], v[96:99], 0
    v_mfma_f32_16x16x32_bf16 v[56:59], v[20:23], v[112:115], 0
    ds_read_b128 v[20:23], v1 offset:192
    s_waitcnt lgkmcnt(2)
    v_mfma_f32_16x16x32_bf16 v[32:35], v[24:27], v[68:71], v[32:35]
    v_mfma_f32_16x16x32_bf16 v[40:43], v[24:27], v[84:87], v[40:43]
    v_mfma_f32_16x16x32_bf16 v[48:51], v[24:27], v[100:103], v[48:51]
    v_mfma_f32_16x16x32_bf16 v[56:59], v[24:27], v[116:119], v[56:59]
    ds_read_b128 v[24:27], v1 offset:512
    s_waitcnt lgkmcnt(2)
    v_mfma_f32_16x16x32_bf16 v[32:35], v[28:31], v[72:75], v[32:35]
    v_mfma_f32_16x16x32_bf16 v[40:43], v[28:31], v[88:91], v[40:43]
    v_mfma_f32_16x16x32_bf16 v[48:51], v[28:31], v[104:107], v[48:51]
    v_mfma_f32_16x16x32_bf16 v[56:59], v[28:31], v[120:123], v[56:59]
    ds_read_b128 v[28:31], v1 offset:576
    s_waitcnt lgkmcnt(2)
    v_mfma_f32_16x16x32_bf16 v[32:35], v[20:23], v[76:79], v[32:35]
    v_mfma_f32_16x16x32_bf16 v[40:43], v[20:23], v[92:95], v[40:43]
    v_mfma_f32_16x16x32_bf16 v[48:51], v[20:23], v[108:111], v[48:51]
    v_mfma_f32_16x16x32_bf16 v[56:59], v[20:23], v[124:127], v[56:59]
    ds_read_b128 v[20:23], v1 offset:640
    s_waitcnt lgkmcnt(2)
    v_mfma_f32_16x16x32_bf16 v[36:39], v[24:27], v[64:67], 0
    v_mfma_f32_16x16x32_bf16 v[44:47], v[24:27], v[80:83], 0
    v_mfma_f32_16x16x32_bf16 v[52:55], v[24:27], v[96:99], 0
    v_mfma_f32_16x16x32_bf16 v[60:63], v[24:27], v[112:115], 0
    ds_read_b128 v[24:27], v1 offset:704
    s_waitcnt lgkmcnt(2)
    v_mfma_f32_16x16x32_bf16 v[36:39], v[28:31], v[68:71], v[36:39]
    v_mfma_f32_16x16x32_bf16 v[44:47], v[28:31], v[84:87], v[44:47]
    v_mfma_f32_16x16x32_bf16 v[52:55], v[28:31], v[100:103], v[52:55]
    v_mfma_f32_16x16x32_bf16 v[60:63], v[28:31], v[116:119], v[60:63]
    s_waitcnt lgkmcnt(1)
    v_mfma_f32_16x16x32_bf16 v[36:39], v[20:23], v[72:75], v[36:39]
    v_mfma_f32_16x16x32_bf16 v[44:47], v[20:23], v[88:91], v[44:47]
    v_mfma_f32_16x16x32_bf16 v[52:55], v[20:23], v[104:107], v[52:55]
    v_mfma_f32_16x16x32_bf16 v[60:63], v[20:23], v[120:123], v[60:63]
    s_waitcnt lgkmcnt(0)
    v_mfma_f32_16x16x32_bf16 v[36:39], v[24:27], v[76:79], v[36:39]
    v_mfma_f32_16x16x32_bf16 v[44:47], v[24:27], v[92:95], v[44:47]
    v_mfma_f32_16x16x32_bf16 v[52:55], v[24:27], v[108:111], v[52:55]
    v_mfma_f32_16x16x32_bf16 v[60:63], v[24:27], v[124:127], v[60:63]
    s_nop 7
    v_max3_f32 v7, v32, v33, v34
    v_max3_f32 v8, v35, v36, v37
    v_max3_f32 v7, v7, v38, v39
    v_max_f32 v7, v7, v8
    v_mov_b32 v8, v7
    s_nop 1
    v_permlane32_swap_b32 v7, v8
    v_max_f32 v7, v7, v8
    v_mov_b32 v8, v7
    s_nop 1
    v_permlane16_swap_b32 v7, v8
    v_max_f32 v7, v7, v8
    v_mul_f32 v7, s65, v7
    v_min_f32 v7, v16, v7
    v_sub_f32 v8, v7, v16
    v_exp_f32 v8, v8
    v_mov_b32 v16, v7
    v_mul_f32 v12, v12, v8
    v_mul_f32 v128, v128, v8
    v_mul_f32 v129, v129, v8
    v_mul_f32 v130, v130, v8
    v_mul_f32 v131, v131, v8
    v_mul_f32 v144, v144, v8
    v_mul_f32 v145, v145, v8
    v_mul_f32 v146, v146, v8
    v_mul_f32 v147, v147, v8
    v_mul_f32 v160, v160, v8
    v_mul_f32 v161, v161, v8
    v_mul_f32 v162, v162, v8
    v_mul_f32 v163, v163, v8
    v_mul_f32 v176, v176, v8
    v_mul_f32 v177, v177, v8
    v_mul_f32 v178, v178, v8
    v_mul_f32 v179, v179, v8
    v_mul_f32 v192, v192, v8
    v_mul_f32 v193, v193, v8
    v_mul_f32 v194, v194, v8
    v_mul_f32 v195, v195, v8
    v_mul_f32 v208, v208, v8
    v_mul_f32 v209, v209, v8
    v_mul_f32 v210, v210, v8
    v_mul_f32 v211, v211, v8
    v_mul_f32 v224, v224, v8
    v_mul_f32 v225, v225, v8
    v_mul_f32 v226, v226, v8
    v_mul_f32 v227, v227, v8
    v_mul_f32 v240, v240, v8
    v_mul_f32 v241, v241, v8
    v_mul_f32 v242, v242, v8
    v_mul_f32 v243, v243, v8
    v_max3_f32 v7, v40, v41, v42
    v_max3_f32 v8, v43, v44, v45
    v_max3_f32 v7, v7, v46, v47
    v_max_f32 v7, v7, v8
    v_mov_b32 v8, v7
    s_nop 1
    v_permlane32_swap_b32 v7, v8
    v_max_f32 v7, v7, v8
    v_mov_b32 v8, v7
    s_nop 1
    v_permlane16_swap_b32 v7, v8
    v_max_f32 v7, v7, v8
    v_mul_f32 v7, s65, v7
    v_min_f32 v7, v17, v7
    v_sub_f32 v8, v7, v17
    v_exp_f32 v8, v8
    v_mov_b32 v17, v7
    v_mul_f32 v13, v13, v8
    v_mul_f32 v132, v132, v8
    v_mul_f32 v133, v133, v8
    v_mul_f32 v134, v134, v8
    v_mul_f32 v135, v135, v8
    v_mul_f32 v148, v148, v8
    v_mul_f32 v149, v149, v8
    v_mul_f32 v150, v150, v8
    v_mul_f32 v151, v151, v8
    v_mul_f32 v164, v164, v8
    v_mul_f32 v165, v165, v8
    v_mul_f32 v166, v166, v8
    v_mul_f32 v167, v167, v8
    v_mul_f32 v180, v180, v8
    v_mul_f32 v181, v181, v8
    v_mul_f32 v182, v182, v8
    v_mul_f32 v183, v183, v8
    v_mul_f32 v196, v196, v8
    v_mul_f32 v197, v197, v8
    v_mul_f32 v198, v198, v8
    v_mul_f32 v199, v199, v8
    v_mul_f32 v212, v212, v8
    v_mul_f32 v213, v213, v8
    v_mul_f32 v214, v214, v8
    v_mul_f32 v215, v215, v8
    v_mul_f32 v228, v228, v8
    v_mul_f32 v229, v229, v8
    v_mul_f32 v230, v230, v8
    v_mul_f32 v231, v231, v8
    v_mul_f32 v244, v244, v8
    v_mul_f32 v245, v245, v8
    v_mul_f32 v246, v246, v8
    v_mul_f32 v247, v247, v8
    v_max3_f32 v7, v48, v49, v50
    v_max3_f32 v8, v51, v52, v53
    v_max3_f32 v7, v7, v54, v55
    v_max_f32 v7, v7, v8
    v_mov_b32 v8, v7
    s_nop 1
    v_permlane32_swap_b32 v7, v8
    v_max_f32 v7, v7, v8
    v_mov_b32 v8, v7
    s_nop 1
    v_permlane16_swap_b32 v7, v8
    v_max_f32 v7, v7, v8
    v_mul_f32 v7, s65, v7
    v_min_f32 v7, v18, v7
    v_sub_f32 v8, v7, v18
    v_exp_f32 v8, v8
    v_mov_b32 v18, v7
    v_mul_f32 v14, v14, v8
    v_mul_f32 v136, v136, v8
    v_mul_f32 v137, v137, v8
    v_mul_f32 v138, v138, v8
    v_mul_f32 v139, v139, v8
    v_mul_f32 v152, v152, v8
    v_mul_f32 v153, v153, v8
    v_mul_f32 v154, v154, v8
    v_mul_f32 v155, v155, v8
    v_mul_f32 v168, v168, v8
    v_mul_f32 v169, v169, v8
    v_mul_f32 v170, v170, v8
    v_mul_f32 v171, v171, v8
    v_mul_f32 v184, v184, v8
    v_mul_f32 v185, v185, v8
    v_mul_f32 v186, v186, v8
    v_mul_f32 v187, v187, v8
    v_mul_f32 v200, v200, v8
    v_mul_f32 v201, v201, v8
    v_mul_f32 v202, v202, v8
    v_mul_f32 v203, v203, v8
    v_mul_f32 v216, v216, v8
    v_mul_f32 v217, v217, v8
    v_mul_f32 v218, v218, v8
    v_mul_f32 v219, v219, v8
    v_mul_f32 v232, v232, v8
    v_mul_f32 v233, v233, v8
    v_mul_f32 v234, v234, v8
    v_mul_f32 v235, v235, v8
    v_mul_f32 v248, v248, v8
    v_mul_f32 v249, v249, v8
    v_mul_f32 v250, v250, v8
    v_mul_f32 v251, v251, v8
    v_max3_f32 v7, v56, v57, v58
    v_max3_f32 v8, v59, v60, v61
    v_max3_f32 v7, v7, v62, v63
    v_max_f32 v7, v7, v8
    v_mov_b32 v8, v7
    s_nop 1
    v_permlane32_swap_b32 v7, v8
    v_max_f32 v7, v7, v8
    v_mov_b32 v8, v7
    s_nop 1
    v_permlane16_swap_b32 v7, v8
    v_max_f32 v7, v7, v8
    v_mul_f32 v7, s65, v7
    v_min_f32 v7, v19, v7
    v_sub_f32 v8, v7, v19
    v_exp_f32 v8, v8
    v_mov_b32 v19, v7
    v_mul_f32 v15, v15, v8
    v_mul_f32 v140, v140, v8
    v_mul_f32 v141, v141, v8
    v_mul_f32 v142, v142, v8
    v_mul_f32 v143, v143, v8
    v_mul_f32 v156, v156, v8
    v_mul_f32 v157, v157, v8
    v_mul_f32 v158, v158, v8
    v_mul_f32 v159, v159, v8
    v_mul_f32 v172, v172, v8
    v_mul_f32 v173, v173, v8
    v_mul_f32 v174, v174, v8
    v_mul_f32 v175, v175, v8
    v_mul_f32 v188, v188, v8
    v_mul_f32 v189, v189, v8
    v_mul_f32 v190, v190, v8
    v_mul_f32 v191, v191, v8
    v_mul_f32 v204, v204, v8
    v_mul_f32 v205, v205, v8
    v_mul_f32 v206, v206, v8
    v_mul_f32 v207, v207, v8
    v_mul_f32 v220, v220, v8
    v_mul_f32 v221, v221, v8
    v_mul_f32 v222, v222, v8
    v_mul_f32 v223, v223, v8
    v_mul_f32 v236, v236, v8
    v_mul_f32 v237, v237, v8
    v_mul_f32 v238, v238, v8
    v_mul_f32 v239, v239, v8
    v_mul_f32 v252, v252, v8
    v_mul_f32 v253, v253, v8
    v_mul_f32 v254, v254, v8
    v_mul_f32 v255, v255, v8
    v_fma_f32 v32, v32, s64, v16
    v_fma_f32 v33, v33, s64, v16
    v_fma_f32 v34, v34, s64, v16
    v_fma_f32 v35, v35, s64, v16
    v_exp_f32 v32, v32
    v_exp_f32 v33, v33
    v_exp_f32 v34, v34
    v_exp_f32 v35, v35
    v_add_f32 v7, v32, v33
    v_add_f32 v11, v34, v35
    v_add_f32 v7, v7, v11
    v_cvt_pk_bf16_f32 v32, v32, v33
    v_cvt_pk_bf16_f32 v33, v34, v35
    v_fma_f32 v40, v40, s64, v17
    v_fma_f32 v41, v41, s64, v17
    v_fma_f32 v42, v42, s64, v17
    v_fma_f32 v43, v43, s64, v17
    v_exp_f32 v40, v40
    v_exp_f32 v41, v41
    v_exp_f32 v42, v42
    v_exp_f32 v43, v43
    v_add_f32 v8, v40, v41
    v_add_f32 v11, v42, v43
    v_add_f32 v8, v8, v11
    v_cvt_pk_bf16_f32 v40, v40, v41
    v_cvt_pk_bf16_f32 v41, v42, v43
    v_fma_f32 v48, v48, s64, v18
    v_fma_f32 v49, v49, s64, v18
    v_fma_f32 v50, v50, s64, v18
    v_fma_f32 v51, v51, s64, v18
    v_exp_f32 v48, v48
    v_exp_f32 v49, v49
    v_exp_f32 v50, v50
    v_exp_f32 v51, v51
    v_add_f32 v9, v48, v49
    v_add_f32 v11, v50, v51
    v_add_f32 v9, v9, v11
    v_cvt_pk_bf16_f32 v48, v48, v49
    v_cvt_pk_bf16_f32 v49, v50, v51
    v_fma_f32 v56, v56, s64, v19
    v_fma_f32 v57, v57, s64, v19
    v_fma_f32 v58, v58, s64, v19
    v_fma_f32 v59, v59, s64, v19
    v_exp_f32 v56, v56
    v_exp_f32 v57, v57
    v_exp_f32 v58, v58
    v_exp_f32 v59, v59
    v_add_f32 v10, v56, v57
    v_add_f32 v11, v58, v59
    v_add_f32 v10, v10, v11
    v_cvt_pk_bf16_f32 v56, v56, v57
    v_cvt_pk_bf16_f32 v57, v58, v59
    s_mov_b32 s68, 2
    s_branch tp1_4a
k_nt3:
    s_lshl_b32 s74, s73, 18
    s_lshl_b32 s75, s73, 6
    s_add_u32 m0, s81, 0
    s_nop 0
    buffer_load_dwordx4 v5, s[8:11], s74 offen lds
    s_add_u32 m0, s81, 0x420
    s_add_u32 s69, s74, 0x2000
    buffer_load_dwordx4 v5, s[8:11], s69 offen lds
    s_lshr_b32 s69, s78, 4
    s_add_u32 m0, s69, 0x18c00
    s_add_u32 s69, s78, s75
    buffer_load_dwordx4 v6, s[4:7], s69 offen lds
    s_lshr_b32 s69, s79, 4
    s_add_u32 m0, s69, 0x18c00
    s_add_u32 s69, s79, s75
    buffer_load_dwordx4 v6, s[4:7], s69 offen lds
    s_add_u32 s73, s73, 1
    s_and_b32 s73, s73, 15
    s_lshl_b32 s74, s73, 18
    s_lshl_b32 s75, s73, 6
    s_add_u32 m0, s81, 0x2100
    s_nop 0
    buffer_load_dwordx4 v5, s[8:11], s74 offen lds
    s_add_u32 m0, s81, 0x2520
    s_add_u32 s69, s74, 0x2000
    buffer_load_dwordx4 v5, s[8:11], s69 offen lds
    s_lshr_b32 s69, s78, 4
    s_add_u32 m0, s69, 0x1c000
    s_add_u32 s69, s78, s75
    buffer_load_dwordx4 v6, s[4:7], s69 offen lds
    s_lshr_b32 s69, s79, 4
    s_add_u32 m0, s69, 0x1c000
    s_add_u32 s69, s79, s75
    buffer_load_dwordx4 v6, s[4:7], s69 offen lds
    s_add_u32 s73, s73, 1
    s_and_b32 s73, s73, 15
    s_lshl_b32 s74, s73, 18
    s_lshl_b32 s75, s73, 6
    s_add_u32 m0, s81, 0x4200
    s_nop 0
    buffer_load_dwordx4 v5, s[8:11], s74 offen lds
    s_add_u32 m0, s81, 0x4620
    s_add_u32 s69, s74, 0x2000
    buffer_load_dwordx4 v5, s[8:11], s69 offen lds
    s_lshr_b32 s69, s78, 4
    s_add_u32 m0, s69, 0x1f400
    s_add_u32 s69, s78, s75
    buffer_load_dwordx4 v6, s[4:7], s69 offen lds
    s_lshr_b32 s69, s79, 4
    s_add_u32 m0, s69, 0x1f400
    s_add_u32 s69, s79, s75
    buffer_load_dwordx4 v6, s[4:7], s69 offen lds
    s_mov_b32 s70, 0
    s_add_u32 m0, s80, 0
    s_nop 0
    buffer_load_dwordx4 v3, s[12:15], s70 offen nt lds
    s_add_u32 m0, s80, 0x310
    s_nop 0
    buffer_load_dwordx4 v3, s[12:15], s70 offen offset:256 nt lds
    s_add_u32 m0, s80, 0x2100
    s_nop 0
    buffer_load_dwordx4 v4, s[16:19], s70 offen nt lds
    s_add_u32 m0, s80, 0x2420
    s_nop 0
    buffer_load_dwordx4 v4, s[16:19], s70 offen offset:256 nt lds
    v_mov_b32 v128, 0
    v_mov_b32 v129, 0
    v_mov_b32 v130, 0
    v_mov_b32 v131, 0
    v_mov_b32 v132, 0
    v_mov_b32 v133, 0
    v_mov_b32 v134, 0
    v_mov_b32 v135, 0
    v_mov_b32 v136, 0
    v_mov_b32 v137, 0
    v_mov_b32 v138, 0
    v_mov_b32 v139, 0
    v_mov_b32 v144, 0
    v_mov_b32 v145, 0
    v_mov_b32 v146, 0
    v_mov_b32 v147, 0
    v_mov_b32 v148, 0
    v_mov_b32 v149, 0
    v_mov_b32 v150, 0
    v_mov_b32 v151, 0
    v_mov_b32 v152, 0
    v_mov_b32 v153, 0
    v_mov_b32 v154, 0
    v_mov_b32 v155, 0
    v_mov_b32 v160, 0
    v_mov_b32 v161, 0
    v_mov_b32 v162, 0
    v_mov_b32 v163, 0
    v_mov_b32 v164, 0
    v_mov_b32 v165, 0
    v_mov_b32 v166, 0
    v_mov_b32 v167, 0
    v_mov_b32 v168, 0
    v_mov_b32 v169, 0
    v_mov_b32 v170, 0
    v_mov_b32 v171, 0
    v_mov_b32 v176, 0
    v_mov_b32 v177, 0
    v_mov_b32 v178, 0
    v_mov_b32 v179, 0
    v_mov_b32 v180, 0
    v_mov_b32 v181, 0
    v_mov_b32 v182, 0
    v_mov_b32 v183, 0
    v_mov_b32 v184, 0
    v_mov_b32 v185, 0
    v_mov_b32 v186, 0
    v_mov_b32 v187, 0
    v_mov_b32 v192, 0
    v_mov_b32 v193, 0
    v_mov_b32 v194, 0
    v_mov_b32 v195, 0
    v_mov_b32 v196, 0
    v_mov_b32 v197, 0
    v_mov_b32 v198, 0
    v_mov_b32 v199, 0
    v_mov_b32 v200, 0
    v_mov_b32 v201, 0
    v_mov_b32 v202, 0
    v_mov_b32 v203, 0
    v_mov_b32 v208, 0
    v_mov_b32 v209, 0
    v_mov_b32 v210, 0
    v_mov_b32 v211, 0
    v_mov_b32 v212, 0
    v_mov_b32 v213, 0
    v_mov_b32 v214, 0
    v_mov_b32 v215, 0
    v_mov_b32 v216, 0
    v_mov_b32 v217, 0
    v_mov_b32 v218, 0
    v_mov_b32 v219, 0
    v_mov_b32 v224, 0
    v_mov_b32 v225, 0
    v_mov_b32 v226, 0
    v_mov_b32 v227, 0
    v_mov_b32 v228, 0
    v_mov_b32 v229, 0
    v_mov_b32 v230, 0
    v_mov_b32 v231, 0
    v_mov_b32 v232, 0
    v_mov_b32 v233, 0
    v_mov_b32 v234, 0
    v_mov_b32 v235, 0
    v_mov_b32 v240, 0
    v_mov_b32 v241, 0
    v_mov_b32 v242, 0
    v_mov_b32 v243, 0
    v_mov_b32 v244, 0
    v_mov_b32 v245, 0
    v_mov_b32 v246, 0
    v_mov_b32 v247, 0
    v_mov_b32 v248, 0
    v_mov_b32 v249, 0
    v_mov_b32 v250, 0
    v_mov_b32 v251, 0
    s_mov_b32 s72, 0
    s_mov_b32 s82, 0
    s_mov_b32 s67, 0
    s_waitcnt vmcnt(12)
    s_barrier
    ds_read_b128 v[32:35], v13 offset:0
    ds_read_b128 v[36:39], v13 offset:1024
    ds_read_b128 v[40:43], v13 offset:2048
    ds_read_b64_tr_b16 v[64:65], v12 offset:0
    ds_read_b64_tr_b16 v[66:67], v12 offset:256
    ds_read_b64_tr_b16 v[68:69], v12 offset:32
    ds_read_b64_tr_b16 v[70:71], v12 offset:288
    ds_read_b64_tr_b16 v[72:73], v12 offset:64
    ds_read_b64_tr_b16 v[74:75], v12 offset:320
    v_mov_b32 v14, v12
    v_add_u32 v15, 0x3400, v13
p1_loop_3:
    s_cmp_eq_u32 s67, 0
    s_cbranch_scc1 p1_w0_3
    s_waitcnt vmcnt(4)
p1_w0_3:
    s_waitcnt vmcnt(8)
    s_barrier
    s_waitcnt lgkmcnt(4)
    v_mfma_f32_16x16x32_bf16 v[128:131], v[64:67], v[32:35], v[128:131]
    v_mfma_f32_16x16x32_bf16 v[132:135], v[64:67], v[36:39], v[132:135]
    v_mfma_f32_16x16x32_bf16 v[136:139], v[64:67], v[40:43], v[136:139]
    ds_read_b64_tr_b16 v[76:77], v14 offset:96
    ds_read_b64_tr_b16 v[78:79], v14 offset:352
    ds_read_b128 v[48:51], v15 offset:0
    ds_read_b128 v[52:55], v15 offset:1024
    ds_read_b128 v[56:59], v15 offset:2048
    s_mul_i32 s77, s72, 0x3400
    s_add_u32 s77, s77, 0x18c00
    s_add_u32 s76, s82, 0x6300
    s_cmp_ge_u32 s76, 0x8400
    s_cselect_b32 s69, 0x8400, 0
    s_sub_u32 s76, s76, s69
    s_add_u32 s76, s76, s81
    s_add_u32 s82, s82, 0x2100
    s_cmp_eq_u32 s82, 0x8400
    s_cselect_b32 s82, 0, s82
    v_add_u32 v16, s82, v12
    s_add_u32 s73, s73, 1
    s_and_b32 s73, s73, 15
    s_lshl_b32 s74, s73, 18
    s_lshl_b32 s75, s73, 6
    s_waitcnt lgkmcnt(7)
    v_mfma_f32_16x16x32_bf16 v[144:147], v[68:71], v[32:35], v[144:147]
    v_mfma_f32_16x16x32_bf16 v[148:151], v[68:71], v[36:39], v[148:151]
    v_mfma_f32_16x16x32_bf16 v[152:155], v[68:71], v[40:43], v[152:155]
    ds_read_b64_tr_b16 v[64:65], v14 offset:128
    ds_read_b64_tr_b16 v[66:67], v14 offset:384
    s_add_u32 m0, s76, 0
    s_nop 0
    buffer_load_dwordx4 v5, s[8:11], s74 offen lds
    s_waitcnt lgkmcnt(7)
    v_mfma_f32_16x16x32_bf16 v[160:163], v[72:75], v[32:35], v[160:163]
    v_mfma_f32_16x16x32_bf16 v[164:167], v[72:75], v[36:39], v[164:167]
    v_mfma_f32_16x16x32_bf16 v[168:171], v[72:75], v[40:43], v[168:171]
    ds_read_b64_tr_b16 v[68:69], v14 offset:160
    ds_read_b64_tr_b16 v[70:71], v14 offset:416
    s_add_u32 m0, s76, 0x420
    s_add_u32 s69, s74, 0x2000
    buffer_load_dwordx4 v5, s[8:11], s69 offen lds
    s_waitcnt lgkmcnt(7)
    v_mfma_f32_16x16x32_bf16 v[176:179], v[76:79], v[32:35], v[176:179]
    v_mfma_f32_16x16x32_bf16 v[180:183], v[76:79], v[36:39], v[180:183]
    v_mfma_f32_16x16x32_bf16 v[184:187], v[76:79], v[40:43], v[184:187]
    ds_read_b64_tr_b16 v[72:73], v14 offset:192
    ds_read_b64_tr_b16 v[74:75], v14 offset:448
    s_waitcnt lgkmcnt(4)
    v_mfma_f32_16x16x32_bf16 v[192:195], v[64:67], v[32:35], v[192:195]
    v_mfma_f32_16x16x32_bf16 v[196:199], v[64:67], v[36:39], v[196:199]
    v_mfma_f32_16x16x32_bf16 v[200:203], v[64:67], v[40:43], v[200:203]
    ds_read_b64_tr_b16 v[76:77], v14 offset:224
    ds_read_b64_tr_b16 v[78:79], v14 offset:480
    s_lshr_b32 s69, s78, 4
    s_add_u32 m0, s69, s77
    s_add_u32 s69, s78, s75
    buffer_load_dwordx4 v6, s[4:7], s69 offen lds
    s_waitcnt lgkmcnt(4)
    v_mfma_f32_16x16x32_bf16 v[208:211], v[68:71], v[32:35], v[208:211]
    v_mfma_f32_16x16x32_bf16 v[212:215], v[68:71], v[36:39], v[212:215]
    v_mfma_f32_16x16x32_bf16 v[216:219], v[68:71], v[40:43], v[216:219]
    ds_read_b64_tr_b16 v[64:65], v16 offset:0
    ds_read_b64_tr_b16 v[66:67], v16 offset:256
    s_lshr_b32 s69, s79, 4
    s_add_u32 m0, s69, s77
    s_add_u32 s69, s79, s75
    buffer_load_dwordx4 v6, s[4:7], s69 offen lds
    s_waitcnt lgkmcnt(4)
    v_mfma_f32_16x16x32_bf16 v[224:227], v[72:75], v[32:35], v[224:227]
    v_mfma_f32_16x16x32_bf16 v[228:231], v[72:75], v[36:39], v[228:231]
    v_mfma_f32_16x16x32_bf16 v[232:235], v[72:75], v[40:43], v[232:235]
    ds_read_b64_tr_b16 v[68:69], v16 offset:32
    ds_read_b64_tr_b16 v[70:71], v16 offset:288
    s_add_u32 s72, s72, 1
    s_cmp_eq_u32 s72, 3
    s_cselect_b32 s72, 0, s72
    s_add_u32 s69, s72, 1
    s_cmp_eq_u32 s69, 3
    s_cselect_b32 s69, 0, s69
    s_mul_i32 s69, s69, 0x3400
    v_add_u32 v15, s69, v13
    s_waitcnt lgkmcnt(4)
    v_mfma_f32_16x16x32_bf16 v[240:243], v[76:79], v[32:35], v[240:243]
    v_mfma_f32_16x16x32_bf16 v[244:247], v[76:79], v[36:39], v[244:247]
    v_mfma_f32_16x16x32_bf16 v[248:251], v[76:79], v[40:43], v[248:251]
    ds_read_b64_tr_b16 v[72:73], v16 offset:64
    ds_read_b64_tr_b16 v[74:75], v16 offset:320
    v_mov_b32 v14, v16
    s_cmp_eq_u32 s67, 0
    s_cbranch_scc1 p1_w1_3
    s_waitcnt vmcnt(4)
p1_w1_3:
    s_waitcnt vmcnt(8)
    s_barrier
    s_waitcnt lgkmcnt(4)
    v_mfma_f32_16x16x32_bf16 v[128:131], v[64:67], v[48:51], v[128:131]
    v_mfma_f32_16x16x32_bf16 v[132:135], v[64:67], v[52:55], v[132:135]
    v_mfma_f32_16x16x32_bf16 v[136:139], v[64:67], v[56:59], v[136:139]
    ds_read_b64_tr_b16 v[76:77], v14 offset:96
    ds_read_b64_tr_b16 v[78:79], v14 offset:352
    ds_read_b128 v[32:35], v15 offset:0
    ds_read_b128 v[36:39], v15 offset:1024
    ds_read_b128 v[40:43], v15 offset:2048
    s_mul_i32 s77, s72, 0x3400
    s_add_u32 s77, s77, 0x18c00
    s_add_u32 s76, s82, 0x6300
    s_cmp_ge_u32 s76, 0x8400
    s_cselect_b32 s69, 0x8400, 0
    s_sub_u32 s76, s76, s69
    s_add_u32 s76, s76, s81
    s_add_u32 s82, s82, 0x2100
    s_cmp_eq_u32 s82, 0x8400
    s_cselect_b32 s82, 0, s82
    v_add_u32 v16, s82, v12
    s_add_u32 s73, s73, 1
    s_and_b32 s73, s73, 15
    s_lshl_b32 s74, s73, 18
    s_lshl_b32 s75, s73, 6
    s_waitcnt lgkmcnt(7)
    v_mfma_f32_16x16x32_bf16 v[144:147], v[68:71], v[48:51], v[144:147]
    v_mfma_f32_16x16x32_bf16 v[148:151], v[68:71], v[52:55], v[148:151]
    v_mfma_f32_16x16x32_bf16 v[152:155], v[68:71], v[56:59], v[152:155]
    ds_read_b64_tr_b16 v[64:65], v14 offset:128
    ds_read_b64_tr_b16 v[66:67], v14 offset:384
    s_add_u32 m0, s76, 0
    s_nop 0
    buffer_load_dwordx4 v5, s[8:11], s74 offen lds
    s_waitcnt lgkmcnt(7)
    v_mfma_f32_16x16x32_bf16 v[160:163], v[72:75], v[48:51], v[160:163]
    v_mfma_f32_16x16x32_bf16 v[164:167], v[72:75], v[52:55], v[164:167]
    v_mfma_f32_16x16x32_bf16 v[168:171], v[72:75], v[56:59], v[168:171]
    ds_read_b64_tr_b16 v[68:69], v14 offset:160
    ds_read_b64_tr_b16 v[70:71], v14 offset:416
    s_add_u32 m0, s76, 0x420
    s_add_u32 s69, s74, 0x2000
    buffer_load_dwordx4 v5, s[8:11], s69 offen lds
    s_waitcnt lgkmcnt(7)
    v_mfma_f32_16x16x32_bf16 v[176:179], v[76:79], v[48:51], v[176:179]
    v_mfma_f32_16x16x32_bf16 v[180:183], v[76:79], v[52:55], v[180:183]
    v_mfma_f32_16x16x32_bf16 v[184:187], v[76:79], v[56:59], v[184:187]
    ds_read_b64_tr_b16 v[72:73], v14 offset:192
    ds_read_b64_tr_b16 v[74:75], v14 offset:448
    s_waitcnt lgkmcnt(4)
    v_mfma_f32_16x16x32_bf16 v[192:195], v[64:67], v[48:51], v[192:195]
    v_mfma_f32_16x16x32_bf16 v[196:199], v[64:67], v[52:55], v[196:199]
    v_mfma_f32_16x16x32_bf16 v[200:203], v[64:67], v[56:59], v[200:203]
    ds_read_b64_tr_b16 v[76:77], v14 offset:224
    ds_read_b64_tr_b16 v[78:79], v14 offset:480
    s_lshr_b32 s69, s78, 4
    s_add_u32 m0, s69, s77
    s_add_u32 s69, s78, s75
    buffer_load_dwordx4 v6, s[4:7], s69 offen lds
    s_waitcnt lgkmcnt(4)
    v_mfma_f32_16x16x32_bf16 v[208:211], v[68:71], v[48:51], v[208:211]
    v_mfma_f32_16x16x32_bf16 v[212:215], v[68:71], v[52:55], v[212:215]
    v_mfma_f32_16x16x32_bf16 v[216:219], v[68:71], v[56:59], v[216:219]
    ds_read_b64_tr_b16 v[64:65], v16 offset:0
    ds_read_b64_tr_b16 v[66:67], v16 offset:256
    s_lshr_b32 s69, s79, 4
    s_add_u32 m0, s69, s77
    s_add_u32 s69, s79, s75
    buffer_load_dwordx4 v6, s[4:7], s69 offen lds
    s_waitcnt lgkmcnt(4)
    v_mfma_f32_16x16x32_bf16 v[224:227], v[72:75], v[48:51], v[224:227]
    v_mfma_f32_16x16x32_bf16 v[228:231], v[72:75], v[52:55], v[228:231]
    v_mfma_f32_16x16x32_bf16 v[232:235], v[72:75], v[56:59], v[232:235]
    ds_read_b64_tr_b16 v[68:69], v16 offset:32
    ds_read_b64_tr_b16 v[70:71], v16 offset:288
    s_add_u32 s72, s72, 1
    s_cmp_eq_u32 s72, 3
    s_cselect_b32 s72, 0, s72
    s_add_u32 s69, s72, 1
    s_cmp_eq_u32 s69, 3
    s_cselect_b32 s69, 0, s69
    s_mul_i32 s69, s69, 0x3400
    v_add_u32 v15, s69, v13
    s_waitcnt lgkmcnt(4)
    v_mfma_f32_16x16x32_bf16 v[240:243], v[76:79], v[48:51], v[240:243]
    v_mfma_f32_16x16x32_bf16 v[244:247], v[76:79], v[52:55], v[244:247]
    v_mfma_f32_16x16x32_bf16 v[248:251], v[76:79], v[56:59], v[248:251]
    ds_read_b64_tr_b16 v[72:73], v16 offset:64
    ds_read_b64_tr_b16 v[74:75], v16 offset:320
    v_mov_b32 v14, v16
    s_add_u32 s67, s67, 1
    s_cmp_lt_u32 s67, 8
    s_cbranch_scc1 p1_loop_3
    s_waitcnt lgkmcnt(0)
    v_cvt_pk_bf16_f32 v64, v128, v129
    v_cvt_pk_bf16_f32 v65, v130, v131
    v_cvt_pk_bf16_f32 v66, v144, v145
    v_cvt_pk_bf16_f32 v67, v146, v147
    s_nop 0
    v_permlane16_swap_b32 v64, v66
    v_permlane16_swap_b32 v65, v67
    v_cvt_pk_bf16_f32 v68, v160, v161
    v_cvt_pk_bf16_f32 v69, v162, v163
    v_cvt_pk_bf16_f32 v70, v176, v177
    v_cvt_pk_bf16_f32 v71, v178, v179
    s_nop 0
    v_permlane16_swap_b32 v68, v70
    v_permlane16_swap_b32 v69, v71
    v_cvt_pk_bf16_f32 v72, v192, v193
    v_cvt_pk_bf16_f32 v73, v194, v195
    v_cvt_pk_bf16_f32 v74, v208, v209
    v_cvt_pk_bf16_f32 v75, v210, v211
    s_nop 0
    v_permlane16_swap_b32 v72, v74
    v_permlane16_swap_b32 v73, v75
    v_cvt_pk_bf16_f32 v76, v224, v225
    v_cvt_pk_bf16_f32 v77, v226, v227
    v_cvt_pk_bf16_f32 v78, v240, v241
    v_cvt_pk_bf16_f32 v79, v242, v243
    s_nop 0
    v_permlane16_swap_b32 v76, v78
    v_permlane16_swap_b32 v77, v79
    v_cvt_pk_bf16_f32 v80, v132, v133
    v_cvt_pk_bf16_f32 v81, v134, v135
    v_cvt_pk_bf16_f32 v82, v148, v149
    v_cvt_pk_bf16_f32 v83, v150, v151
    s_nop 0
    v_permlane16_swap_b32 v80, v82
    v_permlane16_swap_b32 v81, v83
    v_cvt_pk_bf16_f32 v84, v164, v165
    v_cvt_pk_bf16_f32 v85, v166, v167
    v_cvt_pk_bf16_f32 v86, v180, v181
    v_cvt_pk_bf16_f32 v87, v182, v183
    s_nop 0
    v_permlane16_swap_b32 v84, v86
    v_permlane16_swap_b32 v85, v87
    v_cvt_pk_bf16_f32 v88, v196, v197
    v_cvt_pk_bf16_f32 v89, v198, v199
    v_cvt_pk_bf16_f32 v90, v212, v213
    v_cvt_pk_bf16_f32 v91, v214, v215
    s_nop 0
    v_permlane16_swap_b32 v88, v90
    v_permlane16_swap_b32 v89, v91
    v_cvt_pk_bf16_f32 v92, v228, v229
    v_cvt_pk_bf16_f32 v93, v230, v231
    v_cvt_pk_bf16_f32 v94, v244, v245
    v_cvt_pk_bf16_f32 v95, v246, v247
    s_nop 0
    v_permlane16_swap_b32 v92, v94
    v_permlane16_swap_b32 v93, v95
    v_cvt_pk_bf16_f32 v96, v136, v137
    v_cvt_pk_bf16_f32 v97, v138, v139
    v_cvt_pk_bf16_f32 v98, v152, v153
    v_cvt_pk_bf16_f32 v99, v154, v155
    s_nop 0
    v_permlane16_swap_b32 v96, v98
    v_permlane16_swap_b32 v97, v99
    v_cvt_pk_bf16_f32 v100, v168, v169
    v_cvt_pk_bf16_f32 v101, v170, v171
    v_cvt_pk_bf16_f32 v102, v184, v185
    v_cvt_pk_bf16_f32 v103, v186, v187
    s_nop 0
    v_permlane16_swap_b32 v100, v102
    v_permlane16_swap_b32 v101, v103
    v_cvt_pk_bf16_f32 v104, v200, v201
    v_cvt_pk_bf16_f32 v105, v202, v203
    v_cvt_pk_bf16_f32 v106, v216, v217
    v_cvt_pk_bf16_f32 v107, v218, v219
    s_nop 0
    v_permlane16_swap_b32 v104, v106
    v_permlane16_swap_b32 v105, v107
    v_cvt_pk_bf16_f32 v108, v232, v233
    v_cvt_pk_bf16_f32 v109, v234, v235
    v_cvt_pk_bf16_f32 v110, v248, v249
    v_cvt_pk_bf16_f32 v111, v250, v251
    s_nop 0
    v_permlane16_swap_b32 v108, v110
    v_permlane16_swap_b32 v109, v111
    s_mul_i32 s70, s60, 0x4200
    v_and_b32 v11, 15, v0
    v_add_u32 v11, 4, v11
    v_lshrrev_b32 v11, 3, v11
    v_and_b32 v11, 1, v11
    v_and_b32 v10, 15, v0
    v_and_b32 v9, 15, v0
    v_add_u32 v9, 4, v9
    v_lshrrev_b32 v9, 3, v9
    v_and_b32 v9, 1, v9
    v_mul_u32_u24 v9, 4, v9
    v_sub_u32 v10, v10, v9
    v_mul_u32_u24 v11, v11, v10
    v_and_b32 v10, 15, v0
    v_add_u32 v10, 4, v10
    v_lshrrev_b32 v10, 3, v10
    v_and_b32 v10, 1, v10
    v_xor_b32 v10, 1, v10
    v_and_b32 v9, 15, v0
    v_and_b32 v9, 3, v9
    v_and_b32 v8, 15, v0
    v_lshrrev_b32 v8, 3, v8
    v_lshlrev_b32 v8, 2, v8
    v_add_u32 v9, v9, v8
    v_mul_u32_u24 v10, v10, v9
    v_add_u32 v11, v11, v10
    v_mul_u32_u24 v11, 0x400, v11
    v_and_b32 v10, 15, v0
    v_add_u32 v10, 4, v10
    v_lshrrev_b32 v10, 3, v10
    v_and_b32 v10, 1, v10
    v_and_b32 v9, 15, v0
    v_and_b32 v8, 15, v0
    v_add_u32 v8, 4, v8
    v_lshrrev_b32 v8, 3, v8
    v_and_b32 v8, 1, v8
    v_mul_u32_u24 v8, 4, v8
    v_sub_u32 v9, v9, v8
    v_mul_u32_u24 v10, v10, v9
    v_and_b32 v9, 15, v0
    v_add_u32 v9, 4, v9
    v_lshrrev_b32 v9, 3, v9
    v_and_b32 v9, 1, v9
    v_xor_b32 v9, 1, v9
    v_and_b32 v8, 15, v0
    v_and_b32 v8, 3, v8
    v_and_b32 v7, 15, v0
    v_lshrrev_b32 v7, 3, v7
    v_lshlrev_b32 v7, 2, v7
    v_add_u32 v8, v8, v7
    v_mul_u32_u24 v9, v9, v8
    v_add_u32 v10, v10, v9
    v_and_b32 v10, 1, v10
    v_mul_u32_u24 v10, 16, v10
    v_add_u32 v11, v11, v10
    v_and_b32 v10, 15, v0
    v_add_u32 v10, 4, v10
    v_lshrrev_b32 v10, 3, v10
    v_and_b32 v10, 1, v10
    v_and_b32 v9, 15, v0
    v_and_b32 v8, 15, v0
    v_add_u32 v8, 4, v8
    v_lshrrev_b32 v8, 3, v8
    v_and_b32 v8, 1, v8
    v_mul_u32_u24 v8, 4, v8
    v_sub_u32 v9, v9, v8
    v_mul_u32_u24 v10, v10, v9
    v_and_b32 v9, 15, v0
    v_add_u32 v9, 4, v9
    v_lshrrev_b32 v9, 3, v9
    v_and_b32 v9, 1, v9
    v_xor_b32 v9, 1, v9
    v_and_b32 v8, 15, v0
    v_and_b32 v8, 3, v8
    v_and_b32 v7, 15, v0
    v_lshrrev_b32 v7, 3, v7
    v_lshlrev_b32 v7, 2, v7
    v_add_u32 v8, v8, v7
    v_mul_u32_u24 v9, v9, v8
    v_add_u32 v10, v10, v9
    v_lshrrev_b32 v10, 1, v10
    v_mul_u32_u24 v10, 64, v10
    v_add_u32 v11, v11, v10
    v_and_b32 v10, 15, v0
    v_add_u32 v10, 4, v10
    v_lshrrev_b32 v10, 3, v10
    v_and_b32 v10, 1, v10
    v_mul_u32_u24 v10, 0x100, v10
    v_add_u32 v11, v11, v10
    v_lshrrev_b32 v10, 4, v0
    v_and_b32 v10, 3, v10
    v_and_b32 v10, 1, v10
    v_lshlrev_b32 v10, 1, v10
    v_lshrrev_b32 v9, 4, v0
    v_and_b32 v9, 3, v9
    v_lshrrev_b32 v9, 1, v9
    v_or_b32 v10, v10, v9
    v_mul_u32_u24 v10, 16, v10
    v_add_u32 v11, v11, v10
    v_add_u32 v1, s70, v11
    v_lshrrev_b32 v11, 2, v0
    v_and_b32 v11, 3, v11
    v_lshrrev_b32 v10, 4, v0
    v_and_b32 v10, 3, v10
    v_and_b32 v10, 1, v10
    v_lshlrev_b32 v10, 2, v10
    v_add_u32 v11, v11, v10
    v_mul_u32_u24 v11, 0x420, v11
    v_lshrrev_b32 v10, 4, v0
    v_and_b32 v10, 3, v10
    v_lshrrev_b32 v10, 1, v10
    v_mul_u32_u24 v10, 0x100, v10
    v_add_u32 v11, v11, v10
    v_and_b32 v10, 3, v0
    v_mul_u32_u24 v10, 8, v10
    v_add_u32 v11, v11, v10
    v_add_u32 v2, s70, v11
    v_mov_b32 v16, 0x7f800000
    v_mov_b32 v12, 0
    v_mov_b32 v17, 0x7f800000
    v_mov_b32 v13, 0
    v_mov_b32 v18, 0x7f800000
    v_mov_b32 v14, 0
    s_mov_b32 s67, 0
    s_mov_b32 s68, 1
    s_mov_b32 s72, 0x6000
    s_mov_b32 s73, 0
    s_waitcnt vmcnt(0)
    s_barrier
    s_mov_b32 s70, 0x2000
    s_add_u32 m0, s80, 0x8400
    s_nop 0
    buffer_load_dwordx4 v3, s[12:15], s70 offen nt lds
    s_add_u32 m0, s80, 0x8710
    s_nop 0
    buffer_load_dwordx4 v3, s[12:15], s70 offen offset:256 nt lds
    s_add_u32 m0, s80, 0xa500
    s_nop 0
    buffer_load_dwordx4 v4, s[16:19], s70 offen nt lds
    s_add_u32 m0, s80, 0xa820
    s_nop 0
    buffer_load_dwordx4 v4, s[16:19], s70 offen offset:256 nt lds
    s_mov_b32 s70, 0x4000
    s_add_u32 m0, s80, 0x10800
    s_nop 0
    buffer_load_dwordx4 v3, s[12:15], s70 offen nt lds
    s_add_u32 m0, s80, 0x10b10
    s_nop 0
    buffer_load_dwordx4 v3, s[12:15], s70 offen offset:256 nt lds
    s_add_u32 m0, s80, 0x12900
    s_nop 0
    buffer_load_dwordx4 v4, s[16:19], s70 offen nt lds
    s_add_u32 m0, s80, 0x12c20
    s_nop 0
    buffer_load_dwordx4 v4, s[16:19], s70 offen offset:256 nt lds
chunk_top_3a:
    s_waitcnt vmcnt(8)
    s_barrier
    s_cmp_lg_u32 s68, 0
    s_cbranch_scc1 slow_qk_3a
    ds_read_b128 v[20:23], v1 offset:0
    ds_read_b128 v[24:27], v1 offset:64
    ds_read_b128 v[28:31], v1 offset:128
    s_waitcnt lgkmcnt(2)
    v_mfma_f32_16x16x32_bf16 v[32:35], v[20:23], v[64:67], 0
    v_mfma_f32_16x16x32_bf16 v[40:43], v[20:23], v[80:83], 0
    v_mfma_f32_16x16x32_bf16 v[48:51], v[20:23], v[96:99], 0
    ds_read_b128 v[20:23], v1 offset:192
    s_waitcnt lgkmcnt(2)
    v_mfma_f32_16x16x32_bf16 v[32:35], v[24:27], v[68:71], v[32:35]
    v_mfma_f32_16x16x32_bf16 v[40:43], v[24:27], v[84:87], v[40:43]
    v_mfma_f32_16x16x32_bf16 v[48:51], v[24:27], v[100:103], v[48:51]
    ds_read_b128 v[24:27], v1 offset:512
    s_waitcnt lgkmcnt(2)
    v_mfma_f32_16x16x32_bf16 v[32:35], v[28:31], v[72:75], v[32:35]
    v_mfma_f32_16x16x32_bf16 v[40:43], v[28:31], v[88:91], v[40:43]
    v_mfma_f32_16x16x32_bf16 v[48:51], v[28:31], v[104:107], v[48:51]
    ds_read_b128 v[28:31], v1 offset:576
    s_waitcnt lgkmcnt(2)
    v_mfma_f32_16x16x32_bf16 v[32:35], v[20:23], v[76:79], v[32:35]
    v_mfma_f32_16x16x32_bf16 v[40:43], v[20:23], v[92:95], v[40:43]
    v_mfma_f32_16x16x32_bf16 v[48:51], v[20:23], v[108:111], v[48:51]
    ds_read_b128 v[20:23], v1 offset:640
    s_waitcnt lgkmcnt(2)
    v_mfma_f32_16x16x32_bf16 v[36:39], v[24:27], v[64:67], 0
    s_nop 2
    v_fma_f32 v32, v32, s64, v16
    v_fma_f32 v33, v33, s64, v16
    v_fma_f32 v34, v34, s64, v16
    v_fma_f32 v35, v35, s64, v16
    v_mfma_f32_16x16x32_bf16 v[44:47], v[24:27], v[80:83], 0
    v_exp_f32 v32, v32
    v_exp_f32 v33, v33
    v_exp_f32 v34, v34
    v_exp_f32 v35, v35
    v_mfma_f32_16x16x32_bf16 v[52:55], v[24:27], v[96:99], 0
    v_add_f32 v7, v32, v33
    v_add_f32 v11, v34, v35
    v_add_f32 v7, v7, v11
    v_cvt_pk_bf16_f32 v32, v32, v33
    ds_read_b128 v[24:27], v1 offset:704
    s_waitcnt lgkmcnt(2)
    v_mfma_f32_16x16x32_bf16 v[36:39], v[28:31], v[68:71], v[36:39]
    v_cvt_pk_bf16_f32 v33, v34, v35
    v_fma_f32 v40, v40, s64, v17
    v_fma_f32 v41, v41, s64, v17
    v_fma_f32 v42, v42, s64, v17
    v_mfma_f32_16x16x32_bf16 v[44:47], v[28:31], v[84:87], v[44:47]
    v_fma_f32 v43, v43, s64, v17
    v_exp_f32 v40, v40
    v_exp_f32 v41, v41
    v_exp_f32 v42, v42
    v_mfma_f32_16x16x32_bf16 v[52:55], v[28:31], v[100:103], v[52:55]
    v_exp_f32 v43, v43
    v_add_f32 v8, v40, v41
    v_add_f32 v11, v42, v43
    v_add_f32 v8, v8, v11
    s_waitcnt lgkmcnt(1)
    v_mfma_f32_16x16x32_bf16 v[36:39], v[20:23], v[72:75], v[36:39]
    v_cvt_pk_bf16_f32 v40, v40, v41
    v_cvt_pk_bf16_f32 v41, v42, v43
    v_fma_f32 v48, v48, s64, v18
    v_fma_f32 v49, v49, s64, v18
    v_mfma_f32_16x16x32_bf16 v[44:47], v[20:23], v[88:91], v[44:47]
    v_fma_f32 v50, v50, s64, v18
    v_fma_f32 v51, v51, s64, v18
    v_exp_f32 v48, v48
    v_exp_f32 v49, v49
    v_mfma_f32_16x16x32_bf16 v[52:55], v[20:23], v[104:107], v[52:55]
    v_exp_f32 v50, v50
    v_exp_f32 v51, v51
    v_add_f32 v9, v48, v49
    v_add_f32 v11, v50, v51
    s_waitcnt lgkmcnt(0)
    v_mfma_f32_16x16x32_bf16 v[36:39], v[24:27], v[76:79], v[36:39]
    v_add_f32 v9, v9, v11
    v_cvt_pk_bf16_f32 v48, v48, v49
    v_cvt_pk_bf16_f32 v49, v50, v51
    v_mfma_f32_16x16x32_bf16 v[44:47], v[24:27], v[92:95], v[44:47]
    v_mfma_f32_16x16x32_bf16 v[52:55], v[24:27], v[108:111], v[52:55]
tp1_3a:
    s_nop 3
    v_fma_f32 v36, v36, s64, v16
    v_fma_f32 v37, v37, s64, v16
    v_fma_f32 v38, v38, s64, v16
    v_fma_f32 v39, v39, s64, v16
    v_exp_f32 v36, v36
    v_exp_f32 v37, v37
    v_exp_f32 v38, v38
    v_exp_f32 v39, v39
    v_add_f32 v7, v7, v36
    v_add_f32 v11, v37, v38
    v_add_f32 v7, v7, v39
    v_add_f32 v7, v7, v11
    v_fma_f32 v44, v44, s64, v17
    v_fma_f32 v45, v45, s64, v17
    v_fma_f32 v46, v46, s64, v17
    v_fma_f32 v47, v47, s64, v17
    v_exp_f32 v44, v44
    v_exp_f32 v45, v45
    v_exp_f32 v46, v46
    v_exp_f32 v47, v47
    v_add_f32 v8, v8, v44
    v_add_f32 v11, v45, v46
    v_add_f32 v8, v8, v47
    v_add_f32 v8, v8, v11
    v_fma_f32 v52, v52, s64, v18
    v_fma_f32 v53, v53, s64, v18
    v_fma_f32 v54, v54, s64, v18
    v_fma_f32 v55, v55, s64, v18
    v_exp_f32 v52, v52
    v_exp_f32 v53, v53
    v_exp_f32 v54, v54
    v_exp_f32 v55, v55
    v_add_f32 v9, v9, v52
    v_add_f32 v11, v53, v54
    v_add_f32 v9, v9, v55
    v_add_f32 v9, v9, v11
    v_max3_f32 v11, v7, v8, v9
    v_cmp_nge_f32 vcc, s66, v11
    s_cbranch_vccnz redo_3a
cont_3a:
    s_mov_b32 s68, 0
    ds_read_b64_tr_b16 v[20:21], v2 offset:8448
    ds_read_b64_tr_b16 v[22:23], v2 offset:8960
    ds_read_b64_tr_b16 v[24:25], v2 offset:8480
    ds_read_b64_tr_b16 v[26:27], v2 offset:8992
    ds_read_b64_tr_b16 v[28:29], v2 offset:8512
    ds_read_b64_tr_b16 v[30:31], v2 offset:9024
    v_cvt_pk_bf16_f32 v34, v36, v37
    v_cvt_pk_bf16_f32 v35, v38, v39
    v_cvt_pk_bf16_f32 v42, v44, v45
    v_cvt_pk_bf16_f32 v43, v46, v47
    v_cvt_pk_bf16_f32 v50, v52, v53
    v_cvt_pk_bf16_f32 v51, v54, v55
    s_waitcnt lgkmcnt(4)
    v_mfma_f32_16x16x32_bf16 v[128:131], v[20:23], v[32:35], v[128:131]
    v_mfma_f32_16x16x32_bf16 v[132:135], v[20:23], v[40:43], v[132:135]
    v_mfma_f32_16x16x32_bf16 v[136:139], v[20:23], v[48:51], v[136:139]
    ds_read_b64_tr_b16 v[20:21], v2 offset:8544
    ds_read_b64_tr_b16 v[22:23], v2 offset:9056
    v_add_f32 v12, v12, v7
    v_add_f32 v13, v13, v8
    v_add_f32 v14, v14, v9
    s_add_u32 s69, s67, 3
    s_and_b32 s69, s69, 3
    s_mul_i32 s74, s69, 0x8400
    s_add_u32 s74, s74, s80
    s_add_u32 s67, s67, 1
    s_and_b32 s69, s67, 3
    s_mul_i32 s69, s69, 0x8400
    s_sub_u32 s75, s69, s73
    s_mov_b32 s73, s69
    s_waitcnt lgkmcnt(4)
    v_mfma_f32_16x16x32_bf16 v[144:147], v[24:27], v[32:35], v[144:147]
    v_mfma_f32_16x16x32_bf16 v[148:151], v[24:27], v[40:43], v[148:151]
    v_mfma_f32_16x16x32_bf16 v[152:155], v[24:27], v[48:51], v[152:155]
    ds_read_b64_tr_b16 v[24:25], v2 offset:8576
    ds_read_b64_tr_b16 v[26:27], v2 offset:9088
    s_add_u32 m0, s74, 0
    s_nop 0
    buffer_load_dwordx4 v3, s[12:15], s72 offen nt lds
    s_waitcnt lgkmcnt(4)
    v_mfma_f32_16x16x32_bf16 v[160:163], v[28:31], v[32:35], v[160:163]
    v_mfma_f32_16x16x32_bf16 v[164:167], v[28:31], v[40:43], v[164:167]
    v_mfma_f32_16x16x32_bf16 v[168:171], v[28:31], v[48:51], v[168:171]
    ds_read_b64_tr_b16 v[28:29], v2 offset:8608
    ds_read_b64_tr_b16 v[30:31], v2 offset:9120
    s_add_u32 m0, s74, 0x310
    s_nop 0
    buffer_load_dwordx4 v3, s[12:15], s72 offen offset:256 nt lds
    s_waitcnt lgkmcnt(4)
    v_mfma_f32_16x16x32_bf16 v[176:179], v[20:23], v[32:35], v[176:179]
    v_mfma_f32_16x16x32_bf16 v[180:183], v[20:23], v[40:43], v[180:183]
    v_mfma_f32_16x16x32_bf16 v[184:187], v[20:23], v[48:51], v[184:187]
    ds_read_b64_tr_b16 v[20:21], v2 offset:8640
    ds_read_b64_tr_b16 v[22:23], v2 offset:9152
    s_add_u32 m0, s74, 0x2100
    s_nop 0
    buffer_load_dwordx4 v4, s[16:19], s72 offen nt lds
    s_waitcnt lgkmcnt(4)
    v_mfma_f32_16x16x32_bf16 v[192:195], v[24:27], v[32:35], v[192:195]
    v_mfma_f32_16x16x32_bf16 v[196:199], v[24:27], v[40:43], v[196:199]
    v_mfma_f32_16x16x32_bf16 v[200:203], v[24:27], v[48:51], v[200:203]
    ds_read_b64_tr_b16 v[24:25], v2 offset:8672
    ds_read_b64_tr_b16 v[26:27], v2 offset:9184
    s_add_u32 m0, s74, 0x2420
    s_nop 0
    buffer_load_dwordx4 v4, s[16:19], s72 offen offset:256 nt lds
    s_waitcnt lgkmcnt(4)
    v_mfma_f32_16x16x32_bf16 v[208:211], v[28:31], v[32:35], v[208:211]
    v_mfma_f32_16x16x32_bf16 v[212:215], v[28:31], v[40:43], v[212:215]
    v_mfma_f32_16x16x32_bf16 v[216:219], v[28:31], v[48:51], v[216:219]
    s_add_u32 s72, s72, 0x2000
    v_add_u32 v1, s75, v1
    v_add_u32 v2, s75, v2
    s_waitcnt lgkmcnt(2)
    v_mfma_f32_16x16x32_bf16 v[224:227], v[20:23], v[32:35], v[224:227]
    v_mfma_f32_16x16x32_bf16 v[228:231], v[20:23], v[40:43], v[228:231]
    v_mfma_f32_16x16x32_bf16 v[232:235], v[20:23], v[48:51], v[232:235]
    s_waitcnt lgkmcnt(0)
    v_mfma_f32_16x16x32_bf16 v[240:243], v[24:27], v[32:35], v[240:243]
    v_mfma_f32_16x16x32_bf16 v[244:247], v[24:27], v[40:43], v[244:247]
    v_mfma_f32_16x16x32_bf16 v[248:251], v[24:27], v[48:51], v[248:251]
    s_cmp_lt_u32 s67, 16
    s_cbranch_scc1 chunk_top_3a
    v_lshlrev_b32 v7, 4, v0
    s_lshl_b32 s69, s63, 12
    v_add_u32 v7, s69, v7
    v_mov_b32 v8, v12
    s_nop 1
    v_permlane32_swap_b32 v12, v8
    v_add_f32 v12, v12, v8
    v_mov_b32 v8, v12
    s_nop 1
    v_permlane16_swap_b32 v12, v8
    v_add_f32 v12, v12, v8
    v_rcp_f32 v12, v12
    v_mov_b32 v8, v13
    s_nop 1
    v_permlane32_swap_b32 v13, v8
    v_add_f32 v13, v13, v8
    v_mov_b32 v8, v13
    s_nop 1
    v_permlane16_swap_b32 v13, v8
    v_add_f32 v13, v13, v8
    v_rcp_f32 v13, v13
    v_mov_b32 v8, v14
    s_nop 1
    v_permlane32_swap_b32 v14, v8
    v_add_f32 v14, v14, v8
    v_mov_b32 v8, v14
    s_nop 1
    v_permlane16_swap_b32 v14, v8
    v_add_f32 v14, v14, v8
    v_rcp_f32 v14, v14
    s_mov_b32 s69, 0
    v_mul_f32 v128, v128, v12
    v_mul_f32 v144, v144, v12
    v_mul_f32 v129, v129, v12
    v_mul_f32 v145, v145, v12
    v_mul_f32 v130, v130, v12
    v_mul_f32 v146, v146, v12
    v_mul_f32 v131, v131, v12
    v_mul_f32 v147, v147, v12
    v_cvt_pk_bf16_f32 v64, v128, v129
    v_cvt_pk_bf16_f32 v65, v130, v131
    v_cvt_pk_bf16_f32 v66, v144, v145
    v_cvt_pk_bf16_f32 v67, v146, v147
    s_nop 0
    v_permlane16_swap_b32 v64, v66
    v_permlane16_swap_b32 v65, v67
    buffer_store_dwordx4 v[64:67], v7, s[20:23], s69 offen nt
    v_mul_f32 v160, v160, v12
    v_mul_f32 v176, v176, v12
    v_mul_f32 v161, v161, v12
    v_mul_f32 v177, v177, v12
    v_mul_f32 v162, v162, v12
    v_mul_f32 v178, v178, v12
    v_mul_f32 v163, v163, v12
    v_mul_f32 v179, v179, v12
    v_cvt_pk_bf16_f32 v68, v160, v161
    v_cvt_pk_bf16_f32 v69, v162, v163
    v_cvt_pk_bf16_f32 v70, v176, v177
    v_cvt_pk_bf16_f32 v71, v178, v179
    s_nop 0
    v_permlane16_swap_b32 v68, v70
    v_permlane16_swap_b32 v69, v71
    buffer_store_dwordx4 v[68:71], v7, s[20:23], s69 offen offset:1024 nt
    v_mul_f32 v192, v192, v12
    v_mul_f32 v208, v208, v12
    v_mul_f32 v193, v193, v12
    v_mul_f32 v209, v209, v12
    v_mul_f32 v194, v194, v12
    v_mul_f32 v210, v210, v12
    v_mul_f32 v195, v195, v12
    v_mul_f32 v211, v211, v12
    v_cvt_pk_bf16_f32 v72, v192, v193
    v_cvt_pk_bf16_f32 v73, v194, v195
    v_cvt_pk_bf16_f32 v74, v208, v209
    v_cvt_pk_bf16_f32 v75, v210, v211
    s_nop 0
    v_permlane16_swap_b32 v72, v74
    v_permlane16_swap_b32 v73, v75
    buffer_store_dwordx4 v[72:75], v7, s[20:23], s69 offen offset:2048 nt
    v_mul_f32 v224, v224, v12
    v_mul_f32 v240, v240, v12
    v_mul_f32 v225, v225, v12
    v_mul_f32 v241, v241, v12
    v_mul_f32 v226, v226, v12
    v_mul_f32 v242, v242, v12
    v_mul_f32 v227, v227, v12
    v_mul_f32 v243, v243, v12
    v_cvt_pk_bf16_f32 v76, v224, v225
    v_cvt_pk_bf16_f32 v77, v226, v227
    v_cvt_pk_bf16_f32 v78, v240, v241
    v_cvt_pk_bf16_f32 v79, v242, v243
    s_nop 0
    v_permlane16_swap_b32 v76, v78
    v_permlane16_swap_b32 v77, v79
    buffer_store_dwordx4 v[76:79], v7, s[20:23], s69 offen offset:3072 nt
    s_mov_b32 s69, 0x1000
    v_mul_f32 v132, v132, v13
    v_mul_f32 v148, v148, v13
    v_mul_f32 v133, v133, v13
    v_mul_f32 v149, v149, v13
    v_mul_f32 v134, v134, v13
    v_mul_f32 v150, v150, v13
    v_mul_f32 v135, v135, v13
    v_mul_f32 v151, v151, v13
    v_cvt_pk_bf16_f32 v80, v132, v133
    v_cvt_pk_bf16_f32 v81, v134, v135
    v_cvt_pk_bf16_f32 v82, v148, v149
    v_cvt_pk_bf16_f32 v83, v150, v151
    s_nop 0
    v_permlane16_swap_b32 v80, v82
    v_permlane16_swap_b32 v81, v83
    buffer_store_dwordx4 v[80:83], v7, s[20:23], s69 offen nt
    v_mul_f32 v164, v164, v13
    v_mul_f32 v180, v180, v13
    v_mul_f32 v165, v165, v13
    v_mul_f32 v181, v181, v13
    v_mul_f32 v166, v166, v13
    v_mul_f32 v182, v182, v13
    v_mul_f32 v167, v167, v13
    v_mul_f32 v183, v183, v13
    v_cvt_pk_bf16_f32 v84, v164, v165
    v_cvt_pk_bf16_f32 v85, v166, v167
    v_cvt_pk_bf16_f32 v86, v180, v181
    v_cvt_pk_bf16_f32 v87, v182, v183
    s_nop 0
    v_permlane16_swap_b32 v84, v86
    v_permlane16_swap_b32 v85, v87
    buffer_store_dwordx4 v[84:87], v7, s[20:23], s69 offen offset:1024 nt
    v_mul_f32 v196, v196, v13
    v_mul_f32 v212, v212, v13
    v_mul_f32 v197, v197, v13
    v_mul_f32 v213, v213, v13
    v_mul_f32 v198, v198, v13
    v_mul_f32 v214, v214, v13
    v_mul_f32 v199, v199, v13
    v_mul_f32 v215, v215, v13
    v_cvt_pk_bf16_f32 v88, v196, v197
    v_cvt_pk_bf16_f32 v89, v198, v199
    v_cvt_pk_bf16_f32 v90, v212, v213
    v_cvt_pk_bf16_f32 v91, v214, v215
    s_nop 0
    v_permlane16_swap_b32 v88, v90
    v_permlane16_swap_b32 v89, v91
    buffer_store_dwordx4 v[88:91], v7, s[20:23], s69 offen offset:2048 nt
    v_mul_f32 v228, v228, v13
    v_mul_f32 v244, v244, v13
    v_mul_f32 v229, v229, v13
    v_mul_f32 v245, v245, v13
    v_mul_f32 v230, v230, v13
    v_mul_f32 v246, v246, v13
    v_mul_f32 v231, v231, v13
    v_mul_f32 v247, v247, v13
    v_cvt_pk_bf16_f32 v92, v228, v229
    v_cvt_pk_bf16_f32 v93, v230, v231
    v_cvt_pk_bf16_f32 v94, v244, v245
    v_cvt_pk_bf16_f32 v95, v246, v247
    s_nop 0
    v_permlane16_swap_b32 v92, v94
    v_permlane16_swap_b32 v93, v95
    buffer_store_dwordx4 v[92:95], v7, s[20:23], s69 offen offset:3072 nt
    s_mov_b32 s69, 0x2000
    v_mul_f32 v136, v136, v14
    v_mul_f32 v152, v152, v14
    v_mul_f32 v137, v137, v14
    v_mul_f32 v153, v153, v14
    v_mul_f32 v138, v138, v14
    v_mul_f32 v154, v154, v14
    v_mul_f32 v139, v139, v14
    v_mul_f32 v155, v155, v14
    v_cvt_pk_bf16_f32 v96, v136, v137
    v_cvt_pk_bf16_f32 v97, v138, v139
    v_cvt_pk_bf16_f32 v98, v152, v153
    v_cvt_pk_bf16_f32 v99, v154, v155
    s_nop 0
    v_permlane16_swap_b32 v96, v98
    v_permlane16_swap_b32 v97, v99
    buffer_store_dwordx4 v[96:99], v7, s[20:23], s69 offen nt
    v_mul_f32 v168, v168, v14
    v_mul_f32 v184, v184, v14
    v_mul_f32 v169, v169, v14
    v_mul_f32 v185, v185, v14
    v_mul_f32 v170, v170, v14
    v_mul_f32 v186, v186, v14
    v_mul_f32 v171, v171, v14
    v_mul_f32 v187, v187, v14
    v_cvt_pk_bf16_f32 v100, v168, v169
    v_cvt_pk_bf16_f32 v101, v170, v171
    v_cvt_pk_bf16_f32 v102, v184, v185
    v_cvt_pk_bf16_f32 v103, v186, v187
    s_nop 0
    v_permlane16_swap_b32 v100, v102
    v_permlane16_swap_b32 v101, v103
    buffer_store_dwordx4 v[100:103], v7, s[20:23], s69 offen offset:1024 nt
    v_mul_f32 v200, v200, v14
    v_mul_f32 v216, v216, v14
    v_mul_f32 v201, v201, v14
    v_mul_f32 v217, v217, v14
    v_mul_f32 v202, v202, v14
    v_mul_f32 v218, v218, v14
    v_mul_f32 v203, v203, v14
    v_mul_f32 v219, v219, v14
    v_cvt_pk_bf16_f32 v104, v200, v201
    v_cvt_pk_bf16_f32 v105, v202, v203
    v_cvt_pk_bf16_f32 v106, v216, v217
    v_cvt_pk_bf16_f32 v107, v218, v219
    s_nop 0
    v_permlane16_swap_b32 v104, v106
    v_permlane16_swap_b32 v105, v107
    buffer_store_dwordx4 v[104:107], v7, s[20:23], s69 offen offset:2048 nt
    v_mul_f32 v232, v232, v14
    v_mul_f32 v248, v248, v14
    v_mul_f32 v233, v233, v14
    v_mul_f32 v249, v249, v14
    v_mul_f32 v234, v234, v14
    v_mul_f32 v250, v250, v14
    v_mul_f32 v235, v235, v14
    v_mul_f32 v251, v251, v14
    v_cvt_pk_bf16_f32 v108, v232, v233
    v_cvt_pk_bf16_f32 v109, v234, v235
    v_cvt_pk_bf16_f32 v110, v248, v249
    v_cvt_pk_bf16_f32 v111, v250, v251
    s_nop 0
    v_permlane16_swap_b32 v108, v110
    v_permlane16_swap_b32 v109, v111
    buffer_store_dwordx4 v[108:111], v7, s[20:23], s69 offen offset:3072 nt
    s_endpgm
redo_3a:
    s_cmp_eq_u32 s68, 2
    s_cbranch_scc1 cont_3a
slow_qk_3a:
    ds_read_b128 v[20:23], v1 offset:0
    ds_read_b128 v[24:27], v1 offset:64
    ds_read_b128 v[28:31], v1 offset:128
    s_waitcnt lgkmcnt(2)
    v_mfma_f32_16x16x32_bf16 v[32:35], v[20:23], v[64:67], 0
    v_mfma_f32_16x16x32_bf16 v[40:43], v[20:23], v[80:83], 0
    v_mfma_f32_16x16x32_bf16 v[48:51], v[20:23], v[96:99], 0
    ds_read_b128 v[20:23], v1 offset:192
    s_waitcnt lgkmcnt(2)
    v_mfma_f32_16x16x32_bf16 v[32:35], v[24:27], v[68:71], v[32:35]
    v_mfma_f32_16x16x32_bf16 v[40:43], v[24:27], v[84:87], v[40:43]
    v_mfma_f32_16x16x32_bf16 v[48:51], v[24:27], v[100:103], v[48:51]
    ds_read_b128 v[24:27], v1 offset:512
    s_waitcnt lgkmcnt(2)
    v_mfma_f32_16x16x32_bf16 v[32:35], v[28:31], v[72:75], v[32:35]
    v_mfma_f32_16x16x32_bf16 v[40:43], v[28:31], v[88:91], v[40:43]
    v_mfma_f32_16x16x32_bf16 v[48:51], v[28:31], v[104:107], v[48:51]
    ds_read_b128 v[28:31], v1 offset:576
    s_waitcnt lgkmcnt(2)
    v_mfma_f32_16x16x32_bf16 v[32:35], v[20:23], v[76:79], v[32:35]
    v_mfma_f32_16x16x32_bf16 v[40:43], v[20:23], v[92:95], v[40:43]
    v_mfma_f32_16x16x32_bf16 v[48:51], v[20:23], v[108:111], v[48:51]
    ds_read_b128 v[20:23], v1 offset:640
    s_waitcnt lgkmcnt(2)
    v_mfma_f32_16x16x32_bf16 v[36:39], v[24:27], v[64:67], 0
    v_mfma_f32_16x16x32_bf16 v[44:47], v[24:27], v[80:83], 0
    v_mfma_f32_16x16x32_bf16 v[52:55], v[24:27], v[96:99], 0
    ds_read_b128 v[24:27], v1 offset:704
    s_waitcnt lgkmcnt(2)
    v_mfma_f32_16x16x32_bf16 v[36:39], v[28:31], v[68:71], v[36:39]
    v_mfma_f32_16x16x32_bf16 v[44:47], v[28:31], v[84:87], v[44:47]
    v_mfma_f32_16x16x32_bf16 v[52:55], v[28:31], v[100:103], v[52:55]
    s_waitcnt lgkmcnt(1)
    v_mfma_f32_16x16x32_bf16 v[36:39], v[20:23], v[72:75], v[36:39]
    v_mfma_f32_16x16x32_bf16 v[44:47], v[20:23], v[88:91], v[44:47]
    v_mfma_f32_16x16x32_bf16 v[52:55], v[20:23], v[104:107], v[52:55]
    s_waitcnt lgkmcnt(0)
    v_mfma_f32_16x16x32_bf16 v[36:39], v[24:27], v[76:79], v[36:39]
    v_mfma_f32_16x16x32_bf16 v[44:47], v[24:27], v[92:95], v[44:47]
    v_mfma_f32_16x16x32_bf16 v[52:55], v[24:27], v[108:111], v[52:55]
    s_nop 7
    v_max3_f32 v7, v32, v33, v34
    v_max3_f32 v8, v35, v36, v37
    v_max3_f32 v7, v7, v38, v39
    v_max_f32 v7, v7, v8
    v_mov_b32 v8, v7
    s_nop 1
    v_permlane32_swap_b32 v7, v8
    v_max_f32 v7, v7, v8
    v_mov_b32 v8, v7
    s_nop 1
    v_permlane16_swap_b32 v7, v8
    v_max_f32 v7, v7, v8
    v_mul_f32 v7, s65, v7
    v_min_f32 v7, v16, v7
    v_sub_f32 v8, v7, v16
    v_exp_f32 v8, v8
    v_mov_b32 v16, v7
    v_mul_f32 v12, v12, v8
    v_mul_f32 v128, v128, v8
    v_mul_f32 v129, v129, v8
    v_mul_f32 v130, v130, v8
    v_mul_f32 v131, v131, v8
    v_mul_f32 v144, v144, v8
    v_mul_f32 v145, v145, v8
    v_mul_f32 v146, v146, v8
    v_mul_f32 v147, v147, v8
    v_mul_f32 v160, v160, v8
    v_mul_f32 v161, v161, v8
    v_mul_f32 v162, v162, v8
    v_mul_f32 v163, v163, v8
    v_mul_f32 v176, v176, v8
    v_mul_f32 v177, v177, v8
    v_mul_f32 v178, v178, v8
    v_mul_f32 v179, v179, v8
    v_mul_f32 v192, v192, v8
    v_mul_f32 v193, v193, v8
    v_mul_f32 v194, v194, v8
    v_mul_f32 v195, v195, v8
    v_mul_f32 v208, v208, v8
    v_mul_f32 v209, v209, v8
    v_mul_f32 v210, v210, v8
    v_mul_f32 v211, v211, v8
    v_mul_f32 v224, v224, v8
    v_mul_f32 v225, v225, v8
    v_mul_f32 v226, v226, v8
    v_mul_f32 v227, v227, v8
    v_mul_f32 v240, v240, v8
    v_mul_f32 v241, v241, v8
    v_mul_f32 v242, v242, v8
    v_mul_f32 v243, v243, v8
    v_max3_f32 v7, v40, v41, v42
    v_max3_f32 v8, v43, v44, v45
    v_max3_f32 v7, v7, v46, v47
    v_max_f32 v7, v7, v8
    v_mov_b32 v8, v7
    s_nop 1
    v_permlane32_swap_b32 v7, v8
    v_max_f32 v7, v7, v8
    v_mov_b32 v8, v7
    s_nop 1
    v_permlane16_swap_b32 v7, v8
    v_max_f32 v7, v7, v8
    v_mul_f32 v7, s65, v7
    v_min_f32 v7, v17, v7
    v_sub_f32 v8, v7, v17
    v_exp_f32 v8, v8
    v_mov_b32 v17, v7
    v_mul_f32 v13, v13, v8
    v_mul_f32 v132, v132, v8
    v_mul_f32 v133, v133, v8
    v_mul_f32 v134, v134, v8
    v_mul_f32 v135, v135, v8
    v_mul_f32 v148, v148, v8
    v_mul_f32 v149, v149, v8
    v_mul_f32 v150, v150, v8
    v_mul_f32 v151, v151, v8
    v_mul_f32 v164, v164, v8
    v_mul_f32 v165, v165, v8
    v_mul_f32 v166, v166, v8
    v_mul_f32 v167, v167, v8
    v_mul_f32 v180, v180, v8
    v_mul_f32 v181, v181, v8
    v_mul_f32 v182, v182, v8
    v_mul_f32 v183, v183, v8
    v_mul_f32 v196, v196, v8
    v_mul_f32 v197, v197, v8
    v_mul_f32 v198, v198, v8
    v_mul_f32 v199, v199, v8
    v_mul_f32 v212, v212, v8
    v_mul_f32 v213, v213, v8
    v_mul_f32 v214, v214, v8
    v_mul_f32 v215, v215, v8
    v_mul_f32 v228, v228, v8
    v_mul_f32 v229, v229, v8
    v_mul_f32 v230, v230, v8
    v_mul_f32 v231, v231, v8
    v_mul_f32 v244, v244, v8
    v_mul_f32 v245, v245, v8
    v_mul_f32 v246, v246, v8
    v_mul_f32 v247, v247, v8
    v_max3_f32 v7, v48, v49, v50
    v_max3_f32 v8, v51, v52, v53
    v_max3_f32 v7, v7, v54, v55
    v_max_f32 v7, v7, v8
    v_mov_b32 v8, v7
    s_nop 1
    v_permlane32_swap_b32 v7, v8
    v_max_f32 v7, v7, v8
    v_mov_b32 v8, v7
    s_nop 1
    v_permlane16_swap_b32 v7, v8
    v_max_f32 v7, v7, v8
    v_mul_f32 v7, s65, v7
    v_min_f32 v7, v18, v7
    v_sub_f32 v8, v7, v18
    v_exp_f32 v8, v8
    v_mov_b32 v18, v7
    v_mul_f32 v14, v14, v8
    v_mul_f32 v136, v136, v8
    v_mul_f32 v137, v137, v8
    v_mul_f32 v138, v138, v8
    v_mul_f32 v139, v139, v8
    v_mul_f32 v152, v152, v8
    v_mul_f32 v153, v153, v8
    v_mul_f32 v154, v154, v8
    v_mul_f32 v155, v155, v8
    v_mul_f32 v168, v168, v8
    v_mul_f32 v169, v169, v8
    v_mul_f32 v170, v170, v8
    v_mul_f32 v171, v171, v8
    v_mul_f32 v184, v184, v8
    v_mul_f32 v185, v185, v8
    v_mul_f32 v186, v186, v8
    v_mul_f32 v187, v187, v8
    v_mul_f32 v200, v200, v8
    v_mul_f32 v201, v201, v8
    v_mul_f32 v202, v202, v8
    v_mul_f32 v203, v203, v8
    v_mul_f32 v216, v216, v8
    v_mul_f32 v217, v217, v8
    v_mul_f32 v218, v218, v8
    v_mul_f32 v219, v219, v8
    v_mul_f32 v232, v232, v8
    v_mul_f32 v233, v233, v8
    v_mul_f32 v234, v234, v8
    v_mul_f32 v235, v235, v8
    v_mul_f32 v248, v248, v8
    v_mul_f32 v249, v249, v8
    v_mul_f32 v250, v250, v8
    v_mul_f32 v251, v251, v8
    v_fma_f32 v32, v32, s64, v16
    v_fma_f32 v33, v33, s64, v16
    v_fma_f32 v34, v34, s64, v16
    v_fma_f32 v35, v35, s64, v16
    v_exp_f32 v32, v32
    v_exp_f32 v33, v33
    v_exp_f32 v34, v34
    v_exp_f32 v35, v35
    v_add_f32 v7, v32, v33
    v_add_f32 v11, v34, v35
    v_add_f32 v7, v7, v11
    v_cvt_pk_bf16_f32 v32, v32, v33
    v_cvt_pk_bf16_f32 v33, v34, v35
    v_fma_f32 v40, v40, s64, v17
    v_fma_f32 v41, v41, s64, v17
    v_fma_f32 v42, v42, s64, v17
    v_fma_f32 v43, v43, s64, v17
    v_exp_f32 v40, v40
    v_exp_f32 v41, v41
    v_exp_f32 v42, v42
    v_exp_f32 v43, v43
    v_add_f32 v8, v40, v41
    v_add_f32 v11, v42, v43
    v_add_f32 v8, v8, v11
    v_cvt_pk_bf16_f32 v40, v40, v41
    v_cvt_pk_bf16_f32 v41, v42, v43
    v_fma_f32 v48, v48, s64, v18
    v_fma_f32 v49, v49, s64, v18
    v_fma_f32 v50, v50, s64, v18
    v_fma_f32 v51, v51, s64, v18
    v_exp_f32 v48, v48
    v_exp_f32 v49, v49
    v_exp_f32 v50, v50
    v_exp_f32 v51, v51
    v_add_f32 v9, v48, v49
    v_add_f32 v11, v50, v51
    v_add_f32 v9, v9, v11
    v_cvt_pk_bf16_f32 v48, v48, v49
    v_cvt_pk_bf16_f32 v49, v50, v51
    s_mov_b32 s68, 2
    s_branch tp1_3a
k_end:
    s_endpgm

.section .rodata,"a"
.p2align 6
.amdhsa_kernel mha_kernel
  .amdhsa_next_free_vgpr 256
  .amdhsa_next_free_sgpr 102
  .amdhsa_accum_offset 256
  .amdhsa_group_segment_fixed_size 0
  .amdhsa_kernarg_size 104
  .amdhsa_user_sgpr_count 2
  .amdhsa_user_sgpr_kernarg_segment_ptr 1
  .amdhsa_system_sgpr_workgroup_id_x 1
.end_amdhsa_kernel
.text
.globl oproj_kernel
.p2align 8
.type oproj_kernel,@function
oproj_kernel:
    s_cmp_ge_u32 s2, 0x100
    s_cbranch_scc1 k2_end
    s_and_b32 s28, s2, 7
    s_lshr_b32 s29, s2, 3
    s_lshr_b32 s55, s28, 2
    s_and_b32 s56, s28, 3
    s_lshr_b32 s57, s29, 2
    s_and_b32 s61, s29, 3
    s_mul_i32 s58, s55, 40
    s_add_u32 s30, s0, s58
    s_addc_u32 s31, s1, 0
    s_load_dwordx2 s[32:33], s[30:31], 32
    s_load_dwordx2 s[40:41], s[0:1], 0x60
    v_lshrrev_b32 v7, 6, v0
    s_nop 0
    v_readfirstlane_b32 s66, v7
    v_and_b32 v0, 63, v0
    s_lshr_b32 s67, s66, 2
    s_and_b32 s24, s66, 3
    s_mul_i32 s25, s24, 0x840
    s_mul_i32 s68, s67, 0x8400
    s_add_u32 s25, s25, s68
    s_mul_i32 s27, s24, 3
    s_cmp_gt_u32 s24, s67
    s_addc_u32 s27, s27, 0
    v_lshrrev_b32 v11, 2, v0
    v_and_b32 v11, 3, v11
    v_lshrrev_b32 v10, 4, v0
    v_and_b32 v10, 3, v10
    v_and_b32 v10, 1, v10
    v_lshlrev_b32 v10, 2, v10
    v_add_u32 v11, v11, v10
    v_mul_u32_u24 v11, 0x420, v11
    v_lshrrev_b32 v10, 4, v0
    v_and_b32 v10, 3, v10
    v_lshrrev_b32 v10, 1, v10
    v_mul_u32_u24 v10, 0x200, v10
    v_add_u32 v11, v11, v10
    v_and_b32 v10, 3, v0
    v_mul_u32_u24 v10, 8, v10
    v_add_u32 v11, v11, v10
    v_add_u32 v1, s68, v11
    v_mov_b32 v10, s24
    v_mul_u32_u24 v11, 2, v10
    v_and_b32 v11, 3, v11
    v_mov_b32 v9, s24
    v_mul_u32_u24 v10, 2, v9
    v_lshrrev_b32 v10, 2, v10
    v_lshlrev_b32 v10, 4, v10
    v_add_u32 v11, v11, v10
    v_lshrrev_b32 v10, 4, v0
    v_and_b32 v10, 3, v10
    v_and_b32 v10, 1, v10
    v_lshlrev_b32 v10, 2, v10
    v_add_u32 v11, v11, v10
    v_lshrrev_b32 v10, 4, v0
    v_and_b32 v10, 3, v10
    v_lshrrev_b32 v10, 1, v10
    v_lshlrev_b32 v10, 3, v10
    v_add_u32 v11, v11, v10
    v_mul_u32_u24 v11, 0x400, v11
    v_and_b32 v10, 15, v0
    v_mul_u32_u24 v10, 16, v10
    v_add_u32 v5, v11, v10
    v_mov_b32 v11, s27
    v_lshlrev_b32 v10, 12, v11
    v_mul_u32_u24 v11, 16, v0
    v_add_u32 v6, v10, v11
    s_waitcnt lgkmcnt(0)
    s_lshl_b32 s58, s55, 3
    s_add_u32 s58, s58, s57
    s_lshl_b32 s59, s58, 5
    s_lshl_b32 s60, s56, 3
    s_add_u32 s59, s59, s60
    s_mul_i32 s59, s59, 0xd000
    s_add_u32 s4, s40, s59
    s_addc_u32 s5, s41, 0
    s_and_b32 s5, s5, 0xffff
    s_mov_b32 s6, 0x68000
    s_mov_b32 s7, 0x20000
    s_lshl_b32 s59, s56, 20
    s_lshl_b32 s60, s61, 8
    s_add_u32 s59, s59, s60
    s_sub_u32 s60, 0x100000, s60
    s_add_u32 s8, s32, s59
    s_addc_u32 s9, s33, 0
    s_and_b32 s9, s9, 0xffff
    s_mov_b32 s10, s60
    s_mov_b32 s11, 0x20000
    s_lshl_b32 s59, s56, 4
    s_add_u32 s59, s59, s58
    s_lshl_b32 s59, s59, 2
    s_add_u32 s59, s59, s61
    s_mul_i32 s59, s59, 0x1a000
    s_add_u32 s59, s59, 0x2000000
    s_add_u32 s20, s40, s59
    s_addc_u32 s21, s41, 0
    s_and_b32 s21, s21, 0xffff
    s_mov_b32 s22, 0x1a000
    s_mov_b32 s23, 0x20000
    s_cmp_eq_u32 s24, s67
    s_cbranch_scc0 k2_nt3
    s_sub_u32 s65, s67, 2
    s_add_u32 s65, s65, 2
    s_lshr_b32 s63, s65, 2
    s_mul_i32 s63, s63, 0xd000
    s_and_b32 s52, s65, 3
    s_lshl_b32 s52, s52, 10
    s_add_u32 s63, s63, s52
    s_lshl_b32 s64, s65, 15
    s_add_u32 m0, s25, 0
    s_nop 0
    buffer_load_dwordx4 v5, s[8:11], s64 offen lds
    s_add_u32 m0, s25, 32
    s_nop 0
    buffer_load_dwordx4 v5, s[8:11], s64 offen offset:1024 lds
    buffer_load_dwordx4 v[64:67], v6, s[4:7], s63 offen nt
    s_add_u32 s52, s63, 0x1000
    buffer_load_dwordx4 v[68:71], v6, s[4:7], s52 offen nt
    s_add_u32 s52, s63, 0x2000
    buffer_load_dwordx4 v[72:75], v6, s[4:7], s52 offen nt
    s_add_u32 s52, s63, 0x3000
    buffer_load_dwordx4 v[76:79], v6, s[4:7], s52 offen nt
    v_mov_b32 v128, 0
    v_mov_b32 v129, 0
    v_mov_b32 v130, 0
    v_mov_b32 v131, 0
    v_mov_b32 v132, 0
    v_mov_b32 v133, 0
    v_mov_b32 v134, 0
    v_mov_b32 v135, 0
    v_mov_b32 v136, 0
    v_mov_b32 v137, 0
    v_mov_b32 v138, 0
    v_mov_b32 v139, 0
    v_mov_b32 v140, 0
    v_mov_b32 v141, 0
    v_mov_b32 v142, 0
    v_mov_b32 v143, 0
    v_mov_b32 v144, 0
    v_mov_b32 v145, 0
    v_mov_b32 v146, 0
    v_mov_b32 v147, 0
    v_mov_b32 v148, 0
    v_mov_b32 v149, 0
    v_mov_b32 v150, 0
    v_mov_b32 v151, 0
    v_mov_b32 v152, 0
    v_mov_b32 v153, 0
    v_mov_b32 v154, 0
    v_mov_b32 v155, 0
    v_mov_b32 v156, 0
    v_mov_b32 v157, 0
    v_mov_b32 v158, 0
    v_mov_b32 v159, 0
    v_mov_b32 v160, 0
    v_mov_b32 v161, 0
    v_mov_b32 v162, 0
    v_mov_b32 v163, 0
    v_mov_b32 v164, 0
    v_mov_b32 v165, 0
    v_mov_b32 v166, 0
    v_mov_b32 v167, 0
    v_mov_b32 v168, 0
    v_mov_b32 v169, 0
    v_mov_b32 v170, 0
    v_mov_b32 v171, 0
    v_mov_b32 v172, 0
    v_mov_b32 v173, 0
    v_mov_b32 v174, 0
    v_mov_b32 v175, 0
    v_mov_b32 v176, 0
    v_mov_b32 v177, 0
    v_mov_b32 v178, 0
    v_mov_b32 v179, 0
    v_mov_b32 v180, 0
    v_mov_b32 v181, 0
    v_mov_b32 v182, 0
    v_mov_b32 v183, 0
    v_mov_b32 v184, 0
    v_mov_b32 v185, 0
    v_mov_b32 v186, 0
    v_mov_b32 v187, 0
    v_mov_b32 v188, 0
    v_mov_b32 v189, 0
    v_mov_b32 v190, 0
    v_mov_b32 v191, 0
    v_mov_b32 v192, 0
    v_mov_b32 v193, 0
    v_mov_b32 v194, 0
    v_mov_b32 v195, 0
    v_mov_b32 v196, 0
    v_mov_b32 v197, 0
    v_mov_b32 v198, 0
    v_mov_b32 v199, 0
    v_mov_b32 v200, 0
    v_mov_b32 v201, 0
    v_mov_b32 v202, 0
    v_mov_b32 v203, 0
    v_mov_b32 v204, 0
    v_mov_b32 v205, 0
    v_mov_b32 v206, 0
    v_mov_b32 v207, 0
    v_mov_b32 v208, 0
    v_mov_b32 v209, 0
    v_mov_b32 v210, 0
    v_mov_b32 v211, 0
    v_mov_b32 v212, 0
    v_mov_b32 v213, 0
    v_mov_b32 v214, 0
    v_mov_b32 v215, 0
    v_mov_b32 v216, 0
    v_mov_b32 v217, 0
    v_mov_b32 v218, 0
    v_mov_b32 v219, 0
    v_mov_b32 v220, 0
    v_mov_b32 v221, 0
    v_mov_b32 v222, 0
    v_mov_b32 v223, 0
    v_mov_b32 v224, 0
    v_mov_b32 v225, 0
    v_mov_b32 v226, 0
    v_mov_b32 v227, 0
    v_mov_b32 v228, 0
    v_mov_b32 v229, 0
    v_mov_b32 v230, 0
    v_mov_b32 v231, 0
    v_mov_b32 v232, 0
    v_mov_b32 v233, 0
    v_mov_b32 v234, 0
    v_mov_b32 v235, 0
    v_mov_b32 v236, 0
    v_mov_b32 v237, 0
    v_mov_b32 v238, 0
    v_mov_b32 v239, 0
    v_mov_b32 v240, 0
    v_mov_b32 v241, 0
    v_mov_b32 v242, 0
    v_mov_b32 v243, 0
    v_mov_b32 v244, 0
    v_mov_b32 v245, 0
    v_mov_b32 v246, 0
    v_mov_b32 v247, 0
    v_mov_b32 v248, 0
    v_mov_b32 v249, 0
    v_mov_b32 v250, 0
    v_mov_b32 v251, 0
    v_mov_b32 v252, 0
    v_mov_b32 v253, 0
    v_mov_b32 v254, 0
    v_mov_b32 v255, 0
    s_add_u32 s65, s65, 2
    s_lshr_b32 s63, s65, 2
    s_mul_i32 s63, s63, 0xd000
    s_and_b32 s52, s65, 3
    s_lshl_b32 s52, s52, 10
    s_add_u32 s63, s63, s52
    s_lshl_b32 s64, s65, 15
    s_add_u32 m0, s25, 0x2100
    s_nop 0
    buffer_load_dwordx4 v5, s[8:11], s64 offen lds
    s_add_u32 m0, s25, 0x2120
    s_nop 0
    buffer_load_dwordx4 v5, s[8:11], s64 offen offset:1024 lds
    buffer_load_dwordx4 v[80:83], v6, s[4:7], s63 offen nt
    s_add_u32 s52, s63, 0x1000
    buffer_load_dwordx4 v[84:87], v6, s[4:7], s52 offen nt
    s_add_u32 s52, s63, 0x2000
    buffer_load_dwordx4 v[88:91], v6, s[4:7], s52 offen nt
    s_add_u32 s52, s63, 0x3000
    buffer_load_dwordx4 v[92:95], v6, s[4:7], s52 offen nt
    s_add_u32 s65, s65, 2
    s_lshr_b32 s63, s65, 2
    s_mul_i32 s63, s63, 0xd000
    s_and_b32 s52, s65, 3
    s_lshl_b32 s52, s52, 10
    s_add_u32 s63, s63, s52
    s_lshl_b32 s64, s65, 15
    s_add_u32 m0, s25, 0x4200
    s_nop 0
    buffer_load_dwordx4 v5, s[8:11], s64 offen lds
    s_add_u32 m0, s25, 0x4220
    s_nop 0
    buffer_load_dwordx4 v5, s[8:11], s64 offen offset:1024 lds
    buffer_load_dwordx4 v[96:99], v6, s[4:7], s63 offen nt
    s_add_u32 s52, s63, 0x1000
    buffer_load_dwordx4 v[100:103], v6, s[4:7], s52 offen nt
    s_add_u32 s52, s63, 0x2000
    buffer_load_dwordx4 v[104:107], v6, s[4:7], s52 offen nt
    s_add_u32 s52, s63, 0x3000
    buffer_load_dwordx4 v[108:111], v6, s[4:7], s52 offen nt
    s_mov_b32 s44, 0
    s_waitcnt vmcnt(16)
    s_barrier
    ds_read_b64_tr_b16 v[32:33], v1 offset:0
    ds_read_b64_tr_b16 v[34:35], v1 offset:256
    ds_read_b64_tr_b16 v[36:37], v1 offset:32
    ds_read_b64_tr_b16 v[38:39], v1 offset:288
    ds_read_b64_tr_b16 v[40:41], v1 offset:64
    ds_read_b64_tr_b16 v[42:43], v1 offset:320
k2_loop_4:
    s_waitcnt vmcnt(10)
    s_barrier
    s_waitcnt lgkmcnt(4)
    v_mfma_f32_16x16x32_bf16 v[128:131], v[32:35], v[64:67], v[128:131]
    v_mfma_f32_16x16x32_bf16 v[132:135], v[32:35], v[68:71], v[132:135]
    v_mfma_f32_16x16x32_bf16 v[136:139], v[32:35], v[72:75], v[136:139]
    v_mfma_f32_16x16x32_bf16 v[140:143], v[32:35], v[76:79], v[140:143]
    ds_read_b64_tr_b16 v[44:45], v1 offset:96
    ds_read_b64_tr_b16 v[46:47], v1 offset:352
    s_add_u32 s65, s65, 2
    s_lshr_b32 s63, s65, 2
    s_mul_i32 s63, s63, 0xd000
    s_and_b32 s52, s65, 3
    s_lshl_b32 s52, s52, 10
    s_add_u32 s63, s63, s52
    s_lshl_b32 s64, s65, 15
    s_waitcnt lgkmcnt(4)
    v_mfma_f32_16x16x32_bf16 v[144:147], v[36:39], v[64:67], v[144:147]
    v_mfma_f32_16x16x32_bf16 v[148:151], v[36:39], v[68:71], v[148:151]
    v_mfma_f32_16x16x32_bf16 v[152:155], v[36:39], v[72:75], v[152:155]
    v_mfma_f32_16x16x32_bf16 v[156:159], v[36:39], v[76:79], v[156:159]
    ds_read_b64_tr_b16 v[32:33], v1 offset:128
    ds_read_b64_tr_b16 v[34:35], v1 offset:384
    s_add_u32 m0, s25, 0x6300
    s_nop 0
    buffer_load_dwordx4 v5, s[8:11], s64 offen lds
    s_waitcnt lgkmcnt(4)
    v_mfma_f32_16x16x32_bf16 v[160:163], v[40:43], v[64:67], v[160:163]
    v_mfma_f32_16x16x32_bf16 v[164:167], v[40:43], v[68:71], v[164:167]
    v_mfma_f32_16x16x32_bf16 v[168:171], v[40:43], v[72:75], v[168:171]
    v_mfma_f32_16x16x32_bf16 v[172:175], v[40:43], v[76:79], v[172:175]
    ds_read_b64_tr_b16 v[36:37], v1 offset:160
    ds_read_b64_tr_b16 v[38:39], v1 offset:416
    s_add_u32 m0, s25, 0x6320
    s_nop 0
    buffer_load_dwordx4 v5, s[8:11], s64 offen offset:1024 lds
    s_waitcnt lgkmcnt(4)
    v_mfma_f32_16x16x32_bf16 v[176:179], v[44:47], v[64:67], v[176:179]
    v_mfma_f32_16x16x32_bf16 v[180:183], v[44:47], v[68:71], v[180:183]
    v_mfma_f32_16x16x32_bf16 v[184:187], v[44:47], v[72:75], v[184:187]
    v_mfma_f32_16x16x32_bf16 v[188:191], v[44:47], v[76:79], v[188:191]
    ds_read_b64_tr_b16 v[40:41], v1 offset:192
    ds_read_b64_tr_b16 v[42:43], v1 offset:448
    buffer_load_dwordx4 v[112:115], v6, s[4:7], s63 offen nt
    s_waitcnt lgkmcnt(4)
    v_mfma_f32_16x16x32_bf16 v[192:195], v[32:35], v[64:67], v[192:195]
    v_mfma_f32_16x16x32_bf16 v[196:199], v[32:35], v[68:71], v[196:199]
    v_mfma_f32_16x16x32_bf16 v[200:203], v[32:35], v[72:75], v[200:203]
    v_mfma_f32_16x16x32_bf16 v[204:207], v[32:35], v[76:79], v[204:207]
    ds_read_b64_tr_b16 v[44:45], v1 offset:224
    ds_read_b64_tr_b16 v[46:47], v1 offset:480
    s_add_u32 s52, s63, 0x1000
    buffer_load_dwordx4 v[116:119], v6, s[4:7], s52 offen nt
    s_waitcnt lgkmcnt(4)
    v_mfma_f32_16x16x32_bf16 v[208:211], v[36:39], v[64:67], v[208:211]
    v_mfma_f32_16x16x32_bf16 v[212:215], v[36:39], v[68:71], v[212:215]
    v_mfma_f32_16x16x32_bf16 v[216:219], v[36:39], v[72:75], v[216:219]
    v_mfma_f32_16x16x32_bf16 v[220:223], v[36:39], v[76:79], v[220:223]
    ds_read_b64_tr_b16 v[32:33], v1 offset:8448
    ds_read_b64_tr_b16 v[34:35], v1 offset:8704
    s_add_u32 s52, s63, 0x2000
    buffer_load_dwordx4 v[120:123], v6, s[4:7], s52 offen nt
    s_waitcnt lgkmcnt(4)
    v_mfma_f32_16x16x32_bf16 v[224:227], v[40:43], v[64:67], v[224:227]
    v_mfma_f32_16x16x32_bf16 v[228:231], v[40:43], v[68:71], v[228:231]
    v_mfma_f32_16x16x32_bf16 v[232:235], v[40:43], v[72:75], v[232:235]
    v_mfma_f32_16x16x32_bf16 v[236:239], v[40:43], v[76:79], v[236:239]
    ds_read_b64_tr_b16 v[36:37], v1 offset:8480
    ds_read_b64_tr_b16 v[38:39], v1 offset:8736
    s_add_u32 s52, s63, 0x3000
    buffer_load_dwordx4 v[124:127], v6, s[4:7], s52 offen nt
    s_waitcnt lgkmcnt(4)
    v_mfma_f32_16x16x32_bf16 v[240:243], v[44:47], v[64:67], v[240:243]
    v_mfma_f32_16x16x32_bf16 v[244:247], v[44:47], v[68:71], v[244:247]
    v_mfma_f32_16x16x32_bf16 v[248:251], v[44:47], v[72:75], v[248:251]
    v_mfma_f32_16x16x32_bf16 v[252:255], v[44:47], v[76:79], v[252:255]
    ds_read_b64_tr_b16 v[40:41], v1 offset:8512
    ds_read_b64_tr_b16 v[42:43], v1 offset:8768
    s_waitcnt vmcnt(10)
    s_barrier
    s_waitcnt lgkmcnt(4)
    v_mfma_f32_16x16x32_bf16 v[128:131], v[32:35], v[80:83], v[128:131]
    v_mfma_f32_16x16x32_bf16 v[132:135], v[32:35], v[84:87], v[132:135]
    v_mfma_f32_16x16x32_bf16 v[136:139], v[32:35], v[88:91], v[136:139]
    v_mfma_f32_16x16x32_bf16 v[140:143], v[32:35], v[92:95], v[140:143]
    ds_read_b64_tr_b16 v[44:45], v1 offset:8544
    ds_read_b64_tr_b16 v[46:47], v1 offset:8800
    s_add_u32 s65, s65, 2
    s_lshr_b32 s63, s65, 2
    s_mul_i32 s63, s63, 0xd000
    s_and_b32 s52, s65, 3
    s_lshl_b32 s52, s52, 10
    s_add_u32 s63, s63, s52
    s_lshl_b32 s64, s65, 15
    s_waitcnt lgkmcnt(4)
    v_mfma_f32_16x16x32_bf16 v[144:147], v[36:39], v[80:83], v[144:147]
    v_mfma_f32_16x16x32_bf16 v[148:151], v[36:39], v[84:87], v[148:151]
    v_mfma_f32_16x16x32_bf16 v[152:155], v[36:39], v[88:91], v[152:155]
    v_mfma_f32_16x16x32_bf16 v[156:159], v[36:39], v[92:95], v[156:159]
    ds_read_b64_tr_b16 v[32:33], v1 offset:8576
    ds_read_b64_tr_b16 v[34:35], v1 offset:8832
    s_add_u32 m0, s25, 0
    s_nop 0
    buffer_load_dwordx4 v5, s[8:11], s64 offen lds
    s_waitcnt lgkmcnt(4)
    v_mfma_f32_16x16x32_bf16 v[160:163], v[40:43], v[80:83], v[160:163]
    v_mfma_f32_16x16x32_bf16 v[164:167], v[40:43], v[84:87], v[164:167]
    v_mfma_f32_16x16x32_bf16 v[168:171], v[40:43], v[88:91], v[168:171]
    v_mfma_f32_16x16x32_bf16 v[172:175], v[40:43], v[92:95], v[172:175]
    ds_read_b64_tr_b16 v[36:37], v1 offset:8608
    ds_read_b64_tr_b16 v[38:39], v1 offset:8864
    s_add_u32 m0, s25, 32
    s_nop 0
    buffer_load_dwordx4 v5, s[8:11], s64 offen offset:1024 lds
    s_waitcnt lgkmcnt(4)
    v_mfma_f32_16x16x32_bf16 v[176:179], v[44:47], v[80:83], v[176:179]
    v_mfma_f32_16x16x32_bf16 v[180:183], v[44:47], v[84:87], v[180:183]
    v_mfma_f32_16x16x32_bf16 v[184:187], v[44:47], v[88:91], v[184:187]
    v_mfma_f32_16x16x32_bf16 v[188:191], v[44:47], v[92:95], v[188:191]
    ds_read_b64_tr_b16 v[40:41], v1 offset:8640
    ds_read_b64_tr_b16 v[42:43], v1 offset:8896
    buffer_load_dwordx4 v[64:67], v6, s[4:7], s63 offen nt
    s_waitcnt lgkmcnt(4)
    v_mfma_f32_16x16x32_bf16 v[192:195], v[32:35], v[80:83], v[192:195]
    v_mfma_f32_16x16x32_bf16 v[196:199], v[32:35], v[84:87], v[196:199]
    v_mfma_f32_16x16x32_bf16 v[200:203], v[32:35], v[88:91], v[200:203]
    v_mfma_f32_16x16x32_bf16 v[204:207], v[32:35], v[92:95], v[204:207]
    ds_read_b64_tr_b16 v[44:45], v1 offset:8672
    ds_read_b64_tr_b16 v[46:47], v1 offset:8928
    s_add_u32 s52, s63, 0x1000
    buffer_load_dwordx4 v[68:71], v6, s[4:7], s52 offen nt
    s_waitcnt lgkmcnt(4)
    v_mfma_f32_16x16x32_bf16 v[208:211], v[36:39], v[80:83], v[208:211]
    v_mfma_f32_16x16x32_bf16 v[212:215], v[36:39], v[84:87], v[212:215]
    v_mfma_f32_16x16x32_bf16 v[216:219], v[36:39], v[88:91], v[216:219]
    v_mfma_f32_16x16x32_bf16 v[220:223], v[36:39], v[92:95], v[220:223]
    ds_read_b64_tr_b16 v[32:33], v1 offset:16896
    ds_read_b64_tr_b16 v[34:35], v1 offset:17152
    s_add_u32 s52, s63, 0x2000
    buffer_load_dwordx4 v[72:75], v6, s[4:7], s52 offen nt
    s_waitcnt lgkmcnt(4)
    v_mfma_f32_16x16x32_bf16 v[224:227], v[40:43], v[80:83], v[224:227]
    v_mfma_f32_16x16x32_bf16 v[228:231], v[40:43], v[84:87], v[228:231]
    v_mfma_f32_16x16x32_bf16 v[232:235], v[40:43], v[88:91], v[232:235]
    v_mfma_f32_16x16x32_bf16 v[236:239], v[40:43], v[92:95], v[236:239]
    ds_read_b64_tr_b16 v[36:37], v1 offset:16928
    ds_read_b64_tr_b16 v[38:39], v1 offset:17184
    s_add_u32 s52, s63, 0x3000
    buffer_load_dwordx4 v[76:79], v6, s[4:7], s52 offen nt
    s_waitcnt lgkmcnt(4)
    v_mfma_f32_16x16x32_bf16 v[240:243], v[44:47], v[80:83], v[240:243]
    v_mfma_f32_16x16x32_bf16 v[244:247], v[44:47], v[84:87], v[244:247]
    v_mfma_f32_16x16x32_bf16 v[248:251], v[44:47], v[88:91], v[248:251]
    v_mfma_f32_16x16x32_bf16 v[252:255], v[44:47], v[92:95], v[252:255]
    ds_read_b64_tr_b16 v[40:41], v1 offset:16960
    ds_read_b64_tr_b16 v[42:43], v1 offset:17216
    s_waitcnt vmcnt(10)
    s_barrier
    s_waitcnt lgkmcnt(4)
    v_mfma_f32_16x16x32_bf16 v[128:131], v[32:35], v[96:99], v[128:131]
    v_mfma_f32_16x16x32_bf16 v[132:135], v[32:35], v[100:103], v[132:135]
    v_mfma_f32_16x16x32_bf16 v[136:139], v[32:35], v[104:107], v[136:139]
    v_mfma_f32_16x16x32_bf16 v[140:143], v[32:35], v[108:111], v[140:143]
    ds_read_b64_tr_b16 v[44:45], v1 offset:16992
    ds_read_b64_tr_b16 v[46:47], v1 offset:17248
    s_add_u32 s65, s65, 2
    s_lshr_b32 s63, s65, 2
    s_mul_i32 s63, s63, 0xd000
    s_and_b32 s52, s65, 3
    s_lshl_b32 s52, s52, 10
    s_add_u32 s63, s63, s52
    s_lshl_b32 s64, s65, 15
    s_waitcnt lgkmcnt(4)
    v_mfma_f32_16x16x32_bf16 v[144:147], v[36:39], v[96:99], v[144:147]
    v_mfma_f32_16x16x32_bf16 v[148:151], v[36:39], v[100:103], v[148:151]
    v_mfma_f32_16x16x32_bf16 v[152:155], v[36:39], v[104:107], v[152:155]
    v_mfma_f32_16x16x32_bf16 v[156:159], v[36:39], v[108:111], v[156:159]
    ds_read_b64_tr_b16 v[32:33], v1 offset:17024
    ds_read_b64_tr_b16 v[34:35], v1 offset:17280
    s_add_u32 m0, s25, 0x2100
    s_nop 0
    buffer_load_dwordx4 v5, s[8:11], s64 offen lds
    s_waitcnt lgkmcnt(4)
    v_mfma_f32_16x16x32_bf16 v[160:163], v[40:43], v[96:99], v[160:163]
    v_mfma_f32_16x16x32_bf16 v[164:167], v[40:43], v[100:103], v[164:167]
    v_mfma_f32_16x16x32_bf16 v[168:171], v[40:43], v[104:107], v[168:171]
    v_mfma_f32_16x16x32_bf16 v[172:175], v[40:43], v[108:111], v[172:175]
    ds_read_b64_tr_b16 v[36:37], v1 offset:17056
    ds_read_b64_tr_b16 v[38:39], v1 offset:17312
    s_add_u32 m0, s25, 0x2120
    s_nop 0
    buffer_load_dwordx4 v5, s[8:11], s64 offen offset:1024 lds
    s_waitcnt lgkmcnt(4)
    v_mfma_f32_16x16x32_bf16 v[176:179], v[44:47], v[96:99], v[176:179]
    v_mfma_f32_16x16x32_bf16 v[180:183], v[44:47], v[100:103], v[180:183]
    v_mfma_f32_16x16x32_bf16 v[184:187], v[44:47], v[104:107], v[184:187]
    v_mfma_f32_16x16x32_bf16 v[188:191], v[44:47], v[108:111], v[188:191]
    ds_read_b64_tr_b16 v[40:41], v1 offset:17088
    ds_read_b64_tr_b16 v[42:43], v1 offset:17344
    buffer_load_dwordx4 v[80:83], v6, s[4:7], s63 offen nt
    s_waitcnt lgkmcnt(4)
    v_mfma_f32_16x16x32_bf16 v[192:195], v[32:35], v[96:99], v[192:195]
    v_mfma_f32_16x16x32_bf16 v[196:199], v[32:35], v[100:103], v[196:199]
    v_mfma_f32_16x16x32_bf16 v[200:203], v[32:35], v[104:107], v[200:203]
    v_mfma_f32_16x16x32_bf16 v[204:207], v[32:35], v[108:111], v[204:207]
    ds_read_b64_tr_b16 v[44:45], v1 offset:17120
    ds_read_b64_tr_b16 v[46:47], v1 offset:17376
    s_add_u32 s52, s63, 0x1000
    buffer_load_dwordx4 v[84:87], v6, s[4:7], s52 offen nt
    s_waitcnt lgkmcnt(4)
    v_mfma_f32_16x16x32_bf16 v[208:211], v[36:39], v[96:99], v[208:211]
    v_mfma_f32_16x16x32_bf16 v[212:215], v[36:39], v[100:103], v[212:215]
    v_mfma_f32_16x16x32_bf16 v[216:219], v[36:39], v[104:107], v[216:219]
    v_mfma_f32_16x16x32_bf16 v[220:223], v[36:39], v[108:111], v[220:223]
    ds_read_b64_tr_b16 v[32:33], v1 offset:25344
    ds_read_b64_tr_b16 v[34:35], v1 offset:25600
    s_add_u32 s52, s63, 0x2000
    buffer_load_dwordx4 v[88:91], v6, s[4:7], s52 offen nt
    s_waitcnt lgkmcnt(4)
    v_mfma_f32_16x16x32_bf16 v[224:227], v[40:43], v[96:99], v[224:227]
    v_mfma_f32_16x16x32_bf16 v[228:231], v[40:43], v[100:103], v[228:231]
    v_mfma_f32_16x16x32_bf16 v[232:235], v[40:43], v[104:107], v[232:235]
    v_mfma_f32_16x16x32_bf16 v[236:239], v[40:43], v[108:111], v[236:239]
    ds_read_b64_tr_b16 v[36:37], v1 offset:25376
    ds_read_b64_tr_b16 v[38:39], v1 offset:25632
    s_add_u32 s52, s63, 0x3000
    buffer_load_dwordx4 v[92:95], v6, s[4:7], s52 offen nt
    s_waitcnt lgkmcnt(4)
    v_mfma_f32_16x16x32_bf16 v[240:243], v[44:47], v[96:99], v[240:243]
    v_mfma_f32_16x16x32_bf16 v[244:247], v[44:47], v[100:103], v[244:247]
    v_mfma_f32_16x16x32_bf16 v[248:251], v[44:47], v[104:107], v[248:251]
    v_mfma_f32_16x16x32_bf16 v[252:255], v[44:47], v[108:111], v[252:255]
    ds_read_b64_tr_b16 v[40:41], v1 offset:25408
    ds_read_b64_tr_b16 v[42:43], v1 offset:25664
    s_waitcnt vmcnt(10)
    s_barrier
    s_waitcnt lgkmcnt(4)
    v_mfma_f32_16x16x32_bf16 v[128:131], v[32:35], v[112:115], v[128:131]
    v_mfma_f32_16x16x32_bf16 v[132:135], v[32:35], v[116:119], v[132:135]
    v_mfma_f32_16x16x32_bf16 v[136:139], v[32:35], v[120:123], v[136:139]
    v_mfma_f32_16x16x32_bf16 v[140:143], v[32:35], v[124:127], v[140:143]
    ds_read_b64_tr_b16 v[44:45], v1 offset:25440
    ds_read_b64_tr_b16 v[46:47], v1 offset:25696
    s_add_u32 s65, s65, 2
    s_lshr_b32 s63, s65, 2
    s_mul_i32 s63, s63, 0xd000
    s_and_b32 s52, s65, 3
    s_lshl_b32 s52, s52, 10
    s_add_u32 s63, s63, s52
    s_lshl_b32 s64, s65, 15
    s_waitcnt lgkmcnt(4)
    v_mfma_f32_16x16x32_bf16 v[144:147], v[36:39], v[112:115], v[144:147]
    v_mfma_f32_16x16x32_bf16 v[148:151], v[36:39], v[116:119], v[148:151]
    v_mfma_f32_16x16x32_bf16 v[152:155], v[36:39], v[120:123], v[152:155]
    v_mfma_f32_16x16x32_bf16 v[156:159], v[36:39], v[124:127], v[156:159]
    ds_read_b64_tr_b16 v[32:33], v1 offset:25472
    ds_read_b64_tr_b16 v[34:35], v1 offset:25728
    s_add_u32 m0, s25, 0x4200
    s_nop 0
    buffer_load_dwordx4 v5, s[8:11], s64 offen lds
    s_waitcnt lgkmcnt(4)
    v_mfma_f32_16x16x32_bf16 v[160:163], v[40:43], v[112:115], v[160:163]
    v_mfma_f32_16x16x32_bf16 v[164:167], v[40:43], v[116:119], v[164:167]
    v_mfma_f32_16x16x32_bf16 v[168:171], v[40:43], v[120:123], v[168:171]
    v_mfma_f32_16x16x32_bf16 v[172:175], v[40:43], v[124:127], v[172:175]
    ds_read_b64_tr_b16 v[36:37], v1 offset:25504
    ds_read_b64_tr_b16 v[38:39], v1 offset:25760
    s_add_u32 m0, s25, 0x4220
    s_nop 0
    buffer_load_dwordx4 v5, s[8:11], s64 offen offset:1024 lds
    s_waitcnt lgkmcnt(4)
    v_mfma_f32_16x16x32_bf16 v[176:179], v[44:47], v[112:115], v[176:179]
    v_mfma_f32_16x16x32_bf16 v[180:183], v[44:47], v[116:119], v[180:183]
    v_mfma_f32_16x16x32_bf16 v[184:187], v[44:47], v[120:123], v[184:187]
    v_mfma_f32_16x16x32_bf16 v[188:191], v[44:47], v[124:127], v[188:191]
    ds_read_b64_tr_b16 v[40:41], v1 offset:25536
    ds_read_b64_tr_b16 v[42:43], v1 offset:25792
    buffer_load_dwordx4 v[96:99], v6, s[4:7], s63 offen nt
    s_waitcnt lgkmcnt(4)
    v_mfma_f32_16x16x32_bf16 v[192:195], v[32:35], v[112:115], v[192:195]
    v_mfma_f32_16x16x32_bf16 v[196:199], v[32:35], v[116:119], v[196:199]
    v_mfma_f32_16x16x32_bf16 v[200:203], v[32:35], v[120:123], v[200:203]
    v_mfma_f32_16x16x32_bf16 v[204:207], v[32:35], v[124:127], v[204:207]
    ds_read_b64_tr_b16 v[44:45], v1 offset:25568
    ds_read_b64_tr_b16 v[46:47], v1 offset:25824
    s_add_u32 s52, s63, 0x1000
    buffer_load_dwordx4 v[100:103], v6, s[4:7], s52 offen nt
    s_waitcnt lgkmcnt(4)
    v_mfma_f32_16x16x32_bf16 v[208:211], v[36:39], v[112:115], v[208:211]
    v_mfma_f32_16x16x32_bf16 v[212:215], v[36:39], v[116:119], v[212:215]
    v_mfma_f32_16x16x32_bf16 v[216:219], v[36:39], v[120:123], v[216:219]
    v_mfma_f32_16x16x32_bf16 v[220:223], v[36:39], v[124:127], v[220:223]
    ds_read_b64_tr_b16 v[32:33], v1 offset:0
    ds_read_b64_tr_b16 v[34:35], v1 offset:256
    s_add_u32 s52, s63, 0x2000
    buffer_load_dwordx4 v[104:107], v6, s[4:7], s52 offen nt
    s_waitcnt lgkmcnt(4)
    v_mfma_f32_16x16x32_bf16 v[224:227], v[40:43], v[112:115], v[224:227]
    v_mfma_f32_16x16x32_bf16 v[228:231], v[40:43], v[116:119], v[228:231]
    v_mfma_f32_16x16x32_bf16 v[232:235], v[40:43], v[120:123], v[232:235]
    v_mfma_f32_16x16x32_bf16 v[236:239], v[40:43], v[124:127], v[236:239]
    ds_read_b64_tr_b16 v[36:37], v1 offset:32
    ds_read_b64_tr_b16 v[38:39], v1 offset:288
    s_add_u32 s52, s63, 0x3000
    buffer_load_dwordx4 v[108:111], v6, s[4:7], s52 offen nt
    s_waitcnt lgkmcnt(4)
    v_mfma_f32_16x16x32_bf16 v[240:243], v[44:47], v[112:115], v[240:243]
    v_mfma_f32_16x16x32_bf16 v[244:247], v[44:47], v[116:119], v[244:247]
    v_mfma_f32_16x16x32_bf16 v[248:251], v[44:47], v[120:123], v[248:251]
    v_mfma_f32_16x16x32_bf16 v[252:255], v[44:47], v[124:127], v[252:255]
    ds_read_b64_tr_b16 v[40:41], v1 offset:64
    ds_read_b64_tr_b16 v[42:43], v1 offset:320
    s_add_u32 s44, s44, 1
    s_cmp_lt_u32 s44, 4
    s_cbranch_scc1 k2_loop_4
    s_waitcnt vmcnt(0) lgkmcnt(0)
    s_barrier
    v_lshlrev_b32 v7, 4, v0
    s_lshl_b32 s26, s27, 13
    v_add_u32 v7, s26, v7
    s_cmp_eq_u32 s67, 0
    s_cbranch_scc0 k2_g1_4
    ds_write_b128 v7, v[192:195] offset:4096
    ds_write_b128 v7, v[208:211] offset:5120
    ds_write_b128 v7, v[224:227] offset:6144
    ds_write_b128 v7, v[240:243] offset:7168
    ds_write_b128 v7, v[196:199] offset:12288
    ds_write_b128 v7, v[212:215] offset:13312
    ds_write_b128 v7, v[228:231] offset:14336
    ds_write_b128 v7, v[244:247] offset:15360
    ds_write_b128 v7, v[200:203] offset:20480
    ds_write_b128 v7, v[216:219] offset:21504
    ds_write_b128 v7, v[232:235] offset:22528
    ds_write_b128 v7, v[248:251] offset:23552
    ds_write_b128 v7, v[204:207] offset:28672
    ds_write_b128 v7, v[220:223] offset:29696
    ds_write_b128 v7, v[236:239] offset:30720
    ds_write_b128 v7, v[252:255] offset:31744
    s_waitcnt lgkmcnt(0)
    s_barrier
    ds_read_b128 v[64:67], v7 offset:0
    ds_read_b128 v[68:71], v7 offset:1024
    ds_read_b128 v[72:75], v7 offset:2048
    ds_read_b128 v[76:79], v7 offset:3072
    ds_read_b128 v[80:83], v7 offset:8192
    ds_read_b128 v[84:87], v7 offset:9216
    ds_read_b128 v[88:91], v7 offset:10240
    ds_read_b128 v[92:95], v7 offset:11264
    ds_read_b128 v[96:99], v7 offset:16384
    ds_read_b128 v[100:103], v7 offset:17408
    ds_read_b128 v[104:107], v7 offset:18432
    ds_read_b128 v[108:111], v7 offset:19456
    ds_read_b128 v[112:115], v7 offset:24576
    ds_read_b128 v[116:119], v7 offset:25600
    ds_read_b128 v[120:123], v7 offset:26624
    ds_read_b128 v[124:127], v7 offset:27648
    s_waitcnt lgkmcnt(12)
    v_add_f32 v128, v128, v64
    v_add_f32 v129, v129, v65
    v_add_f32 v130, v130, v66
    v_add_f32 v131, v131, v67
    v_add_f32 v144, v144, v68
    v_add_f32 v145, v145, v69
    v_add_f32 v146, v146, v70
    v_add_f32 v147, v147, v71
    v_add_f32 v160, v160, v72
    v_add_f32 v161, v161, v73
    v_add_f32 v162, v162, v74
    v_add_f32 v163, v163, v75
    v_add_f32 v176, v176, v76
    v_add_f32 v177, v177, v77
    v_add_f32 v178, v178, v78
    v_add_f32 v179, v179, v79
    s_mov_b32 s52, 0
    buffer_store_dwordx4 v[128:131], v7, s[20:23], s52 offen
    buffer_store_dwordx4 v[144:147], v7, s[20:23], s52 offen offset:1024
    buffer_store_dwordx4 v[160:163], v7, s[20:23], s52 offen offset:2048
    buffer_store_dwordx4 v[176:179], v7, s[20:23], s52 offen offset:3072
    s_waitcnt lgkmcnt(8)
    v_add_f32 v132, v132, v80
    v_add_f32 v133, v133, v81
    v_add_f32 v134, v134, v82
    v_add_f32 v135, v135, v83
    v_add_f32 v148, v148, v84
    v_add_f32 v149, v149, v85
    v_add_f32 v150, v150, v86
    v_add_f32 v151, v151, v87
    v_add_f32 v164, v164, v88
    v_add_f32 v165, v165, v89
    v_add_f32 v166, v166, v90
    v_add_f32 v167, v167, v91
    v_add_f32 v180, v180, v92
    v_add_f32 v181, v181, v93
    v_add_f32 v182, v182, v94
    v_add_f32 v183, v183, v95
    s_mov_b32 s52, 0x2000
    buffer_store_dwordx4 v[132:135], v7, s[20:23], s52 offen
    buffer_store_dwordx4 v[148:151], v7, s[20:23], s52 offen offset:1024
    buffer_store_dwordx4 v[164:167], v7, s[20:23], s52 offen offset:2048
    buffer_store_dwordx4 v[180:183], v7, s[20:23], s52 offen offset:3072
    s_waitcnt lgkmcnt(4)
    v_add_f32 v136, v136, v96
    v_add_f32 v137, v137, v97
    v_add_f32 v138, v138, v98
    v_add_f32 v139, v139, v99
    v_add_f32 v152, v152, v100
    v_add_f32 v153, v153, v101
    v_add_f32 v154, v154, v102
    v_add_f32 v155, v155, v103
    v_add_f32 v168, v168, v104
    v_add_f32 v169, v169, v105
    v_add_f32 v170, v170, v106
    v_add_f32 v171, v171, v107
    v_add_f32 v184, v184, v108
    v_add_f32 v185, v185, v109
    v_add_f32 v186, v186, v110
    v_add_f32 v187, v187, v111
    s_mov_b32 s52, 0x4000
    buffer_store_dwordx4 v[136:139], v7, s[20:23], s52 offen
    buffer_store_dwordx4 v[152:155], v7, s[20:23], s52 offen offset:1024
    buffer_store_dwordx4 v[168:171], v7, s[20:23], s52 offen offset:2048
    buffer_store_dwordx4 v[184:187], v7, s[20:23], s52 offen offset:3072
    s_waitcnt lgkmcnt(0)
    v_add_f32 v140, v140, v112
    v_add_f32 v141, v141, v113
    v_add_f32 v142, v142, v114
    v_add_f32 v143, v143, v115
    v_add_f32 v156, v156, v116
    v_add_f32 v157, v157, v117
    v_add_f32 v158, v158, v118
    v_add_f32 v159, v159, v119
    v_add_f32 v172, v172, v120
    v_add_f32 v173, v173, v121
    v_add_f32 v174, v174, v122
    v_add_f32 v175, v175, v123
    v_add_f32 v188, v188, v124
    v_add_f32 v189, v189, v125
    v_add_f32 v190, v190, v126
    v_add_f32 v191, v191, v127
    s_mov_b32 s52, 0x6000
    buffer_store_dwordx4 v[140:143], v7, s[20:23], s52 offen
    buffer_store_dwordx4 v[156:159], v7, s[20:23], s52 offen offset:1024
    buffer_store_dwordx4 v[172:175], v7, s[20:23], s52 offen offset:2048
    buffer_store_dwordx4 v[188:191], v7, s[20:23], s52 offen offset:3072
    s_endpgm
k2_g1_4:
    ds_write_b128 v7, v[128:131] offset:0
    ds_write_b128 v7, v[144:147] offset:1024
    ds_write_b128 v7, v[160:163] offset:2048
    ds_write_b128 v7, v[176:179] offset:3072
    ds_write_b128 v7, v[132:135] offset:8192
    ds_write_b128 v7, v[148:151] offset:9216
    ds_write_b128 v7, v[164:167] offset:10240
    ds_write_b128 v7, v[180:183] offset:11264
    ds_write_b128 v7, v[136:139] offset:16384
    ds_write_b128 v7, v[152:155] offset:17408
    ds_write_b128 v7, v[168:171] offset:18432
    ds_write_b128 v7, v[184:187] offset:19456
    ds_write_b128 v7, v[140:143] offset:24576
    ds_write_b128 v7, v[156:159] offset:25600
    ds_write_b128 v7, v[172:175] offset:26624
    ds_write_b128 v7, v[188:191] offset:27648
    s_waitcnt lgkmcnt(0)
    s_barrier
    ds_read_b128 v[64:67], v7 offset:4096
    ds_read_b128 v[68:71], v7 offset:5120
    ds_read_b128 v[72:75], v7 offset:6144
    ds_read_b128 v[76:79], v7 offset:7168
    ds_read_b128 v[80:83], v7 offset:12288
    ds_read_b128 v[84:87], v7 offset:13312
    ds_read_b128 v[88:91], v7 offset:14336
    ds_read_b128 v[92:95], v7 offset:15360
    ds_read_b128 v[96:99], v7 offset:20480
    ds_read_b128 v[100:103], v7 offset:21504
    ds_read_b128 v[104:107], v7 offset:22528
    ds_read_b128 v[108:111], v7 offset:23552
    ds_read_b128 v[112:115], v7 offset:28672
    ds_read_b128 v[116:119], v7 offset:29696
    ds_read_b128 v[120:123], v7 offset:30720
    ds_read_b128 v[124:127], v7 offset:31744
    s_waitcnt lgkmcnt(12)
    v_add_f32 v192, v192, v64
    v_add_f32 v193, v193, v65
    v_add_f32 v194, v194, v66
    v_add_f32 v195, v195, v67
    v_add_f32 v208, v208, v68
    v_add_f32 v209, v209, v69
    v_add_f32 v210, v210, v70
    v_add_f32 v211, v211, v71
    v_add_f32 v224, v224, v72
    v_add_f32 v225, v225, v73
    v_add_f32 v226, v226, v74
    v_add_f32 v227, v227, v75
    v_add_f32 v240, v240, v76
    v_add_f32 v241, v241, v77
    v_add_f32 v242, v242, v78
    v_add_f32 v243, v243, v79
    s_mov_b32 s52, 0x1000
    buffer_store_dwordx4 v[192:195], v7, s[20:23], s52 offen
    buffer_store_dwordx4 v[208:211], v7, s[20:23], s52 offen offset:1024
    buffer_store_dwordx4 v[224:227], v7, s[20:23], s52 offen offset:2048
    buffer_store_dwordx4 v[240:243], v7, s[20:23], s52 offen offset:3072
    s_waitcnt lgkmcnt(8)
    v_add_f32 v196, v196, v80
    v_add_f32 v197, v197, v81
    v_add_f32 v198, v198, v82
    v_add_f32 v199, v199, v83
    v_add_f32 v212, v212, v84
    v_add_f32 v213, v213, v85
    v_add_f32 v214, v214, v86
    v_add_f32 v215, v215, v87
    v_add_f32 v228, v228, v88
    v_add_f32 v229, v229, v89
    v_add_f32 v230, v230, v90
    v_add_f32 v231, v231, v91
    v_add_f32 v244, v244, v92
    v_add_f32 v245, v245, v93
    v_add_f32 v246, v246, v94
    v_add_f32 v247, v247, v95
    s_mov_b32 s52, 0x3000
    buffer_store_dwordx4 v[196:199], v7, s[20:23], s52 offen
    buffer_store_dwordx4 v[212:215], v7, s[20:23], s52 offen offset:1024
    buffer_store_dwordx4 v[228:231], v7, s[20:23], s52 offen offset:2048
    buffer_store_dwordx4 v[244:247], v7, s[20:23], s52 offen offset:3072
    s_waitcnt lgkmcnt(4)
    v_add_f32 v200, v200, v96
    v_add_f32 v201, v201, v97
    v_add_f32 v202, v202, v98
    v_add_f32 v203, v203, v99
    v_add_f32 v216, v216, v100
    v_add_f32 v217, v217, v101
    v_add_f32 v218, v218, v102
    v_add_f32 v219, v219, v103
    v_add_f32 v232, v232, v104
    v_add_f32 v233, v233, v105
    v_add_f32 v234, v234, v106
    v_add_f32 v235, v235, v107
    v_add_f32 v248, v248, v108
    v_add_f32 v249, v249, v109
    v_add_f32 v250, v250, v110
    v_add_f32 v251, v251, v111
    s_mov_b32 s52, 0x5000
    buffer_store_dwordx4 v[200:203], v7, s[20:23], s52 offen
    buffer_store_dwordx4 v[216:219], v7, s[20:23], s52 offen offset:1024
    buffer_store_dwordx4 v[232:235], v7, s[20:23], s52 offen offset:2048
    buffer_store_dwordx4 v[248:251], v7, s[20:23], s52 offen offset:3072
    s_waitcnt lgkmcnt(0)
    v_add_f32 v204, v204, v112
    v_add_f32 v205, v205, v113
    v_add_f32 v206, v206, v114
    v_add_f32 v207, v207, v115
    v_add_f32 v220, v220, v116
    v_add_f32 v221, v221, v117
    v_add_f32 v222, v222, v118
    v_add_f32 v223, v223, v119
    v_add_f32 v236, v236, v120
    v_add_f32 v237, v237, v121
    v_add_f32 v238, v238, v122
    v_add_f32 v239, v239, v123
    v_add_f32 v252, v252, v124
    v_add_f32 v253, v253, v125
    v_add_f32 v254, v254, v126
    v_add_f32 v255, v255, v127
    s_mov_b32 s52, 0x7000
    buffer_store_dwordx4 v[204:207], v7, s[20:23], s52 offen
    buffer_store_dwordx4 v[220:223], v7, s[20:23], s52 offen offset:1024
    buffer_store_dwordx4 v[236:239], v7, s[20:23], s52 offen offset:2048
    buffer_store_dwordx4 v[252:255], v7, s[20:23], s52 offen offset:3072
    s_endpgm
k2_nt3:
    s_sub_u32 s65, s67, 2
    s_add_u32 s65, s65, 2
    s_lshr_b32 s63, s65, 2
    s_mul_i32 s63, s63, 0xd000
    s_and_b32 s52, s65, 3
    s_lshl_b32 s52, s52, 10
    s_add_u32 s63, s63, s52
    s_lshl_b32 s64, s65, 15
    s_add_u32 m0, s25, 0
    s_nop 0
    buffer_load_dwordx4 v5, s[8:11], s64 offen lds
    s_add_u32 m0, s25, 32
    s_nop 0
    buffer_load_dwordx4 v5, s[8:11], s64 offen offset:1024 lds
    buffer_load_dwordx4 v[64:67], v6, s[4:7], s63 offen nt
    s_add_u32 s52, s63, 0x1000
    buffer_load_dwordx4 v[68:71], v6, s[4:7], s52 offen nt
    s_add_u32 s52, s63, 0x2000
    buffer_load_dwordx4 v[72:75], v6, s[4:7], s52 offen nt
    v_mov_b32 v128, 0
    v_mov_b32 v129, 0
    v_mov_b32 v130, 0
    v_mov_b32 v131, 0
    v_mov_b32 v132, 0
    v_mov_b32 v133, 0
    v_mov_b32 v134, 0
    v_mov_b32 v135, 0
    v_mov_b32 v136, 0
    v_mov_b32 v137, 0
    v_mov_b32 v138, 0
    v_mov_b32 v139, 0
    v_mov_b32 v144, 0
    v_mov_b32 v145, 0
    v_mov_b32 v146, 0
    v_mov_b32 v147, 0
    v_mov_b32 v148, 0
    v_mov_b32 v149, 0
    v_mov_b32 v150, 0
    v_mov_b32 v151, 0
    v_mov_b32 v152, 0
    v_mov_b32 v153, 0
    v_mov_b32 v154, 0
    v_mov_b32 v155, 0
    v_mov_b32 v160, 0
    v_mov_b32 v161, 0
    v_mov_b32 v162, 0
    v_mov_b32 v163, 0
    v_mov_b32 v164, 0
    v_mov_b32 v165, 0
    v_mov_b32 v166, 0
    v_mov_b32 v167, 0
    v_mov_b32 v168, 0
    v_mov_b32 v169, 0
    v_mov_b32 v170, 0
    v_mov_b32 v171, 0
    v_mov_b32 v176, 0
    v_mov_b32 v177, 0
    v_mov_b32 v178, 0
    v_mov_b32 v179, 0
    v_mov_b32 v180, 0
    v_mov_b32 v181, 0
    v_mov_b32 v182, 0
    v_mov_b32 v183, 0
    v_mov_b32 v184, 0
    v_mov_b32 v185, 0
    v_mov_b32 v186, 0
    v_mov_b32 v187, 0
    v_mov_b32 v192, 0
    v_mov_b32 v193, 0
    v_mov_b32 v194, 0
    v_mov_b32 v195, 0
    v_mov_b32 v196, 0
    v_mov_b32 v197, 0
    v_mov_b32 v198, 0
    v_mov_b32 v199, 0
    v_mov_b32 v200, 0
    v_mov_b32 v201, 0
    v_mov_b32 v202, 0
    v_mov_b32 v203, 0
    v_mov_b32 v208, 0
    v_mov_b32 v209, 0
    v_mov_b32 v210, 0
    v_mov_b32 v211, 0
    v_mov_b32 v212, 0
    v_mov_b32 v213, 0
    v_mov_b32 v214, 0
    v_mov_b32 v215, 0
    v_mov_b32 v216, 0
    v_mov_b32 v217, 0
    v_mov_b32 v218, 0
    v_mov_b32 v219, 0
    v_mov_b32 v224, 0
    v_mov_b32 v225, 0
    v_mov_b32 v226, 0
    v_mov_b32 v227, 0
    v_mov_b32 v228, 0
    v_mov_b32 v229, 0
    v_mov_b32 v230, 0
    v_mov_b32 v231, 0
    v_mov_b32 v232, 0
    v_mov_b32 v233, 0
    v_mov_b32 v234, 0
    v_mov_b32 v235, 0
    v_mov_b32 v240, 0
    v_mov_b32 v241, 0
    v_mov_b32 v242, 0
    v_mov_b32 v243, 0
    v_mov_b32 v244, 0
    v_mov_b32 v245, 0
    v_mov_b32 v246, 0
    v_mov_b32 v247, 0
    v_mov_b32 v248, 0
    v_mov_b32 v249, 0
    v_mov_b32 v250, 0
    v_mov_b32 v251, 0
    s_add_u32 s65, s65, 2
    s_lshr_b32 s63, s65, 2
    s_mul_i32 s63, s63, 0xd000
    s_and_b32 s52, s65, 3
    s_lshl_b32 s52, s52, 10
    s_add_u32 s63, s63, s52
    s_lshl_b32 s64, s65, 15
    s_add_u32 m0, s25, 0x2100
    s_nop 0
    buffer_load_dwordx4 v5, s[8:11], s64 offen lds
    s_add_u32 m0, s25, 0x2120
    s_nop 0
    buffer_load_dwordx4 v5, s[8:11], s64 offen offset:1024 lds
    buffer_load_dwordx4 v[80:83], v6, s[4:7], s63 offen nt
    s_add_u32 s52, s63, 0x1000
    buffer_load_dwordx4 v[84:87], v6, s[4:7], s52 offen nt
    s_add_u32 s52, s63, 0x2000
    buffer_load_dwordx4 v[88:91], v6, s[4:7], s52 offen nt
    s_add_u32 s65, s65, 2
    s_lshr_b32 s63, s65, 2
    s_mul_i32 s63, s63, 0xd000
    s_and_b32 s52, s65, 3
    s_lshl_b32 s52, s52, 10
    s_add_u32 s63, s63, s52
    s_lshl_b32 s64, s65, 15
    s_add_u32 m0, s25, 0x4200
    s_nop 0
    buffer_load_dwordx4 v5, s[8:11], s64 offen lds
    s_add_u32 m0, s25, 0x4220
    s_nop 0
    buffer_load_dwordx4 v5, s[8:11], s64 offen offset:1024 lds
    buffer_load_dwordx4 v[96:99], v6, s[4:7], s63 offen nt
    s_add_u32 s52, s63, 0x1000
    buffer_load_dwordx4 v[100:103], v6, s[4:7], s52 offen nt
    s_add_u32 s52, s63, 0x2000
    buffer_load_dwordx4 v[104:107], v6, s[4:7], s52 offen nt
    s_mov_b32 s44, 0
    s_waitcnt vmcnt(13)
    s_barrier
    ds_read_b64_tr_b16 v[32:33], v1 offset:0
    ds_read_b64_tr_b16 v[34:35], v1 offset:256
    ds_read_b64_tr_b16 v[36:37], v1 offset:32
    ds_read_b64_tr_b16 v[38:39], v1 offset:288
    ds_read_b64_tr_b16 v[40:41], v1 offset:64
    ds_read_b64_tr_b16 v[42:43], v1 offset:320
k2_loop_3:
    s_waitcnt vmcnt(8)
    s_barrier
    s_waitcnt lgkmcnt(4)
    v_mfma_f32_16x16x32_bf16 v[128:131], v[32:35], v[64:67], v[128:131]
    v_mfma_f32_16x16x32_bf16 v[132:135], v[32:35], v[68:71], v[132:135]
    v_mfma_f32_16x16x32_bf16 v[136:139], v[32:35], v[72:75], v[136:139]
    ds_read_b64_tr_b16 v[44:45], v1 offset:96
    ds_read_b64_tr_b16 v[46:47], v1 offset:352
    s_add_u32 s65, s65, 2
    s_lshr_b32 s63, s65, 2
    s_mul_i32 s63, s63, 0xd000
    s_and_b32 s52, s65, 3
    s_lshl_b32 s52, s52, 10
    s_add_u32 s63, s63, s52
    s_lshl_b32 s64, s65, 15
    s_waitcnt lgkmcnt(4)
    v_mfma_f32_16x16x32_bf16 v[144:147], v[36:39], v[64:67], v[144:147]
    v_mfma_f32_16x16x32_bf16 v[148:151], v[36:39], v[68:71], v[148:151]
    v_mfma_f32_16x16x32_bf16 v[152:155], v[36:39], v[72:75], v[152:155]
    ds_read_b64_tr_b16 v[32:33], v1 offset:128
    ds_read_b64_tr_b16 v[34:35], v1 offset:384
    s_add_u32 m0, s25, 0x6300
    s_nop 0
    buffer_load_dwordx4 v5, s[8:11], s64 offen lds
    s_waitcnt lgkmcnt(4)
    v_mfma_f32_16x16x32_bf16 v[160:163], v[40:43], v[64:67], v[160:163]
    v_mfma_f32_16x16x32_bf16 v[164:167], v[40:43], v[68:71], v[164:167]
    v_mfma_f32_16x16x32_bf16 v[168:171], v[40:43], v[72:75], v[168:171]
    ds_read_b64_tr_b16 v[36:37], v1 offset:160
    ds_read_b64_tr_b16 v[38:39], v1 offset:416
    s_add_u32 m0, s25, 0x6320
    s_nop 0
    buffer_load_dwordx4 v5, s[8:11], s64 offen offset:1024 lds
    s_waitcnt lgkmcnt(4)
    v_mfma_f32_16x16x32_bf16 v[176:179], v[44:47], v[64:67], v[176:179]
    v_mfma_f32_16x16x32_bf16 v[180:183], v[44:47], v[68:71], v[180:183]
    v_mfma_f32_16x16x32_bf16 v[184:187], v[44:47], v[72:75], v[184:187]
    ds_read_b64_tr_b16 v[40:41], v1 offset:192
    ds_read_b64_tr_b16 v[42:43], v1 offset:448
    buffer_load_dwordx4 v[112:115], v6, s[4:7], s63 offen nt
    s_waitcnt lgkmcnt(4)
    v_mfma_f32_16x16x32_bf16 v[192:195], v[32:35], v[64:67], v[192:195]
    v_mfma_f32_16x16x32_bf16 v[196:199], v[32:35], v[68:71], v[196:199]
    v_mfma_f32_16x16x32_bf16 v[200:203], v[32:35], v[72:75], v[200:203]
    ds_read_b64_tr_b16 v[44:45], v1 offset:224
    ds_read_b64_tr_b16 v[46:47], v1 offset:480
    s_add_u32 s52, s63, 0x1000
    buffer_load_dwordx4 v[116:119], v6, s[4:7], s52 offen nt
    s_waitcnt lgkmcnt(4)
    v_mfma_f32_16x16x32_bf16 v[208:211], v[36:39], v[64:67], v[208:211]
    v_mfma_f32_16x16x32_bf16 v[212:215], v[36:39], v[68:71], v[212:215]
    v_mfma_f32_16x16x32_bf16 v[216:219], v[36:39], v[72:75], v[216:219]
    ds_read_b64_tr_b16 v[32:33], v1 offset:8448
    ds_read_b64_tr_b16 v[34:35], v1 offset:8704
    s_add_u32 s52, s63, 0x2000
    buffer_load_dwordx4 v[120:123], v6, s[4:7], s52 offen nt
    s_waitcnt lgkmcnt(4)
    v_mfma_f32_16x16x32_bf16 v[224:227], v[40:43], v[64:67], v[224:227]
    v_mfma_f32_16x16x32_bf16 v[228:231], v[40:43], v[68:71], v[228:231]
    v_mfma_f32_16x16x32_bf16 v[232:235], v[40:43], v[72:75], v[232:235]
    ds_read_b64_tr_b16 v[36:37], v1 offset:8480
    ds_read_b64_tr_b16 v[38:39], v1 offset:8736
    s_waitcnt lgkmcnt(4)
    v_mfma_f32_16x16x32_bf16 v[240:243], v[44:47], v[64:67], v[240:243]
    v_mfma_f32_16x16x32_bf16 v[244:247], v[44:47], v[68:71], v[244:247]
    v_mfma_f32_16x16x32_bf16 v[248:251], v[44:47], v[72:75], v[248:251]
    ds_read_b64_tr_b16 v[40:41], v1 offset:8512
    ds_read_b64_tr_b16 v[42:43], v1 offset:8768
    s_waitcnt vmcnt(8)
    s_barrier
    s_waitcnt lgkmcnt(4)
    v_mfma_f32_16x16x32_bf16 v[128:131], v[32:35], v[80:83], v[128:131]
    v_mfma_f32_16x16x32_bf16 v[132:135], v[32:35], v[84:87], v[132:135]
    v_mfma_f32_16x16x32_bf16 v[136:139], v[32:35], v[88:91], v[136:139]
    ds_read_b64_tr_b16 v[44:45], v1 offset:8544
    ds_read_b64_tr_b16 v[46:47], v1 offset:8800
    s_add_u32 s65, s65, 2
    s_lshr_b32 s63, s65, 2
    s_mul_i32 s63, s63, 0xd000
    s_and_b32 s52, s65, 3
    s_lshl_b32 s52, s52, 10
    s_add_u32 s63, s63, s52
    s_lshl_b32 s64, s65, 15
    s_waitcnt lgkmcnt(4)
    v_mfma_f32_16x16x32_bf16 v[144:147], v[36:39], v[80:83], v[144:147]
    v_mfma_f32_16x16x32_bf16 v[148:151], v[36:39], v[84:87], v[148:151]
    v_mfma_f32_16x16x32_bf16 v[152:155], v[36:39], v[88:91], v[152:155]
    ds_read_b64_tr_b16 v[32:33], v1 offset:8576
    ds_read_b64_tr_b16 v[34:35], v1 offset:8832
    s_add_u32 m0, s25, 0
    s_nop 0
    buffer_load_dwordx4 v5, s[8:11], s64 offen lds
    s_waitcnt lgkmcnt(4)
    v_mfma_f32_16x16x32_bf16 v[160:163], v[40:43], v[80:83], v[160:163]
    v_mfma_f32_16x16x32_bf16 v[164:167], v[40:43], v[84:87], v[164:167]
    v_mfma_f32_16x16x32_bf16 v[168:171], v[40:43], v[88:91], v[168:171]
    ds_read_b64_tr_b16 v[36:37], v1 offset:8608
    ds_read_b64_tr_b16 v[38:39], v1 offset:8864
    s_add_u32 m0, s25, 32
    s_nop 0
    buffer_load_dwordx4 v5, s[8:11], s64 offen offset:1024 lds
    s_waitcnt lgkmcnt(4)
    v_mfma_f32_16x16x32_bf16 v[176:179], v[44:47], v[80:83], v[176:179]
    v_mfma_f32_16x16x32_bf16 v[180:183], v[44:47], v[84:87], v[180:183]
    v_mfma_f32_16x16x32_bf16 v[184:187], v[44:47], v[88:91], v[184:187]
    ds_read_b64_tr_b16 v[40:41], v1 offset:8640
    ds_read_b64_tr_b16 v[42:43], v1 offset:8896
    buffer_load_dwordx4 v[64:67], v6, s[4:7], s63 offen nt
    s_waitcnt lgkmcnt(4)
    v_mfma_f32_16x16x32_bf16 v[192:195], v[32:35], v[80:83], v[192:195]
    v_mfma_f32_16x16x32_bf16 v[196:199], v[32:35], v[84:87], v[196:199]
    v_mfma_f32_16x16x32_bf16 v[200:203], v[32:35], v[88:91], v[200:203]
    ds_read_b64_tr_b16 v[44:45], v1 offset:8672
    ds_read_b64_tr_b16 v[46:47], v1 offset:8928
    s_add_u32 s52, s63, 0x1000
    buffer_load_dwordx4 v[68:71], v6, s[4:7], s52 offen nt
    s_waitcnt lgkmcnt(4)
    v_mfma_f32_16x16x32_bf16 v[208:211], v[36:39], v[80:83], v[208:211]
    v_mfma_f32_16x16x32_bf16 v[212:215], v[36:39], v[84:87], v[212:215]
    v_mfma_f32_16x16x32_bf16 v[216:219], v[36:39], v[88:91], v[216:219]
    ds_read_b64_tr_b16 v[32:33], v1 offset:16896
    ds_read_b64_tr_b16 v[34:35], v1 offset:17152
    s_add_u32 s52, s63, 0x2000
    buffer_load_dwordx4 v[72:75], v6, s[4:7], s52 offen nt
    s_waitcnt lgkmcnt(4)
    v_mfma_f32_16x16x32_bf16 v[224:227], v[40:43], v[80:83], v[224:227]
    v_mfma_f32_16x16x32_bf16 v[228:231], v[40:43], v[84:87], v[228:231]
    v_mfma_f32_16x16x32_bf16 v[232:235], v[40:43], v[88:91], v[232:235]
    ds_read_b64_tr_b16 v[36:37], v1 offset:16928
    ds_read_b64_tr_b16 v[38:39], v1 offset:17184
    s_waitcnt lgkmcnt(4)
    v_mfma_f32_16x16x32_bf16 v[240:243], v[44:47], v[80:83], v[240:243]
    v_mfma_f32_16x16x32_bf16 v[244:247], v[44:47], v[84:87], v[244:247]
    v_mfma_f32_16x16x32_bf16 v[248:251], v[44:47], v[88:91], v[248:251]
    ds_read_b64_tr_b16 v[40:41], v1 offset:16960
    ds_read_b64_tr_b16 v[42:43], v1 offset:17216
    s_waitcnt vmcnt(8)
    s_barrier
    s_waitcnt lgkmcnt(4)
    v_mfma_f32_16x16x32_bf16 v[128:131], v[32:35], v[96:99], v[128:131]
    v_mfma_f32_16x16x32_bf16 v[132:135], v[32:35], v[100:103], v[132:135]
    v_mfma_f32_16x16x32_bf16 v[136:139], v[32:35], v[104:107], v[136:139]
    ds_read_b64_tr_b16 v[44:45], v1 offset:16992
    ds_read_b64_tr_b16 v[46:47], v1 offset:17248
    s_add_u32 s65, s65, 2
    s_lshr_b32 s63, s65, 2
    s_mul_i32 s63, s63, 0xd000
    s_and_b32 s52, s65, 3
    s_lshl_b32 s52, s52, 10
    s_add_u32 s63, s63, s52
    s_lshl_b32 s64, s65, 15
    s_waitcnt lgkmcnt(4)
    v_mfma_f32_16x16x32_bf16 v[144:147], v[36:39], v[96:99], v[144:147]
    v_mfma_f32_16x16x32_bf16 v[148:151], v[36:39], v[100:103], v[148:151]
    v_mfma_f32_16x16x32_bf16 v[152:155], v[36:39], v[104:107], v[152:155]
    ds_read_b64_tr_b16 v[32:33], v1 offset:17024
    ds_read_b64_tr_b16 v[34:35], v1 offset:17280
    s_add_u32 m0, s25, 0x2100
    s_nop 0
    buffer_load_dwordx4 v5, s[8:11], s64 offen lds
    s_waitcnt lgkmcnt(4)
    v_mfma_f32_16x16x32_bf16 v[160:163], v[40:43], v[96:99], v[160:163]
    v_mfma_f32_16x16x32_bf16 v[164:167], v[40:43], v[100:103], v[164:167]
    v_mfma_f32_16x16x32_bf16 v[168:171], v[40:43], v[104:107], v[168:171]
    ds_read_b64_tr_b16 v[36:37], v1 offset:17056
    ds_read_b64_tr_b16 v[38:39], v1 offset:17312
    s_add_u32 m0, s25, 0x2120
    s_nop 0
    buffer_load_dwordx4 v5, s[8:11], s64 offen offset:1024 lds
    s_waitcnt lgkmcnt(4)
    v_mfma_f32_16x16x32_bf16 v[176:179], v[44:47], v[96:99], v[176:179]
    v_mfma_f32_16x16x32_bf16 v[180:183], v[44:47], v[100:103], v[180:183]
    v_mfma_f32_16x16x32_bf16 v[184:187], v[44:47], v[104:107], v[184:187]
    ds_read_b64_tr_b16 v[40:41], v1 offset:17088
    ds_read_b64_tr_b16 v[42:43], v1 offset:17344
    buffer_load_dwordx4 v[80:83], v6, s[4:7], s63 offen nt
    s_waitcnt lgkmcnt(4)
    v_mfma_f32_16x16x32_bf16 v[192:195], v[32:35], v[96:99], v[192:195]
    v_mfma_f32_16x16x32_bf16 v[196:199], v[32:35], v[100:103], v[196:199]
    v_mfma_f32_16x16x32_bf16 v[200:203], v[32:35], v[104:107], v[200:203]
    ds_read_b64_tr_b16 v[44:45], v1 offset:17120
    ds_read_b64_tr_b16 v[46:47], v1 offset:17376
    s_add_u32 s52, s63, 0x1000
    buffer_load_dwordx4 v[84:87], v6, s[4:7], s52 offen nt
    s_waitcnt lgkmcnt(4)
    v_mfma_f32_16x16x32_bf16 v[208:211], v[36:39], v[96:99], v[208:211]
    v_mfma_f32_16x16x32_bf16 v[212:215], v[36:39], v[100:103], v[212:215]
    v_mfma_f32_16x16x32_bf16 v[216:219], v[36:39], v[104:107], v[216:219]
    ds_read_b64_tr_b16 v[32:33], v1 offset:25344
    ds_read_b64_tr_b16 v[34:35], v1 offset:25600
    s_add_u32 s52, s63, 0x2000
    buffer_load_dwordx4 v[88:91], v6, s[4:7], s52 offen nt
    s_waitcnt lgkmcnt(4)
    v_mfma_f32_16x16x32_bf16 v[224:227], v[40:43], v[96:99], v[224:227]
    v_mfma_f32_16x16x32_bf16 v[228:231], v[40:43], v[100:103], v[228:231]
    v_mfma_f32_16x16x32_bf16 v[232:235], v[40:43], v[104:107], v[232:235]
    ds_read_b64_tr_b16 v[36:37], v1 offset:25376
    ds_read_b64_tr_b16 v[38:39], v1 offset:25632
    s_waitcnt lgkmcnt(4)
    v_mfma_f32_16x16x32_bf16 v[240:243], v[44:47], v[96:99], v[240:243]
    v_mfma_f32_16x16x32_bf16 v[244:247], v[44:47], v[100:103], v[244:247]
    v_mfma_f32_16x16x32_bf16 v[248:251], v[44:47], v[104:107], v[248:251]
    ds_read_b64_tr_b16 v[40:41], v1 offset:25408
    ds_read_b64_tr_b16 v[42:43], v1 offset:25664
    s_waitcnt vmcnt(8)
    s_barrier
    s_waitcnt lgkmcnt(4)
    v_mfma_f32_16x16x32_bf16 v[128:131], v[32:35], v[112:115], v[128:131]
    v_mfma_f32_16x16x32_bf16 v[132:135], v[32:35], v[116:119], v[132:135]
    v_mfma_f32_16x16x32_bf16 v[136:139], v[32:35], v[120:123], v[136:139]
    ds_read_b64_tr_b16 v[44:45], v1 offset:25440
    ds_read_b64_tr_b16 v[46:47], v1 offset:25696
    s_add_u32 s65, s65, 2
    s_lshr_b32 s63, s65, 2
    s_mul_i32 s63, s63, 0xd000
    s_and_b32 s52, s65, 3
    s_lshl_b32 s52, s52, 10
    s_add_u32 s63, s63, s52
    s_lshl_b32 s64, s65, 15
    s_waitcnt lgkmcnt(4)
    v_mfma_f32_16x16x32_bf16 v[144:147], v[36:39], v[112:115], v[144:147]
    v_mfma_f32_16x16x32_bf16 v[148:151], v[36:39], v[116:119], v[148:151]
    v_mfma_f32_16x16x32_bf16 v[152:155], v[36:39], v[120:123], v[152:155]
    ds_read_b64_tr_b16 v[32:33], v1 offset:25472
    ds_read_b64_tr_b16 v[34:35], v1 offset:25728
    s_add_u32 m0, s25, 0x4200
    s_nop 0
    buffer_load_dwordx4 v5, s[8:11], s64 offen lds
    s_waitcnt lgkmcnt(4)
    v_mfma_f32_16x16x32_bf16 v[160:163], v[40:43], v[112:115], v[160:163]
    v_mfma_f32_16x16x32_bf16 v[164:167], v[40:43], v[116:119], v[164:167]
    v_mfma_f32_16x16x32_bf16 v[168:171], v[40:43], v[120:123], v[168:171]
    ds_read_b64_tr_b16 v[36:37], v1 offset:25504
    ds_read_b64_tr_b16 v[38:39], v1 offset:25760
    s_add_u32 m0, s25, 0x4220
    s_nop 0
    buffer_load_dwordx4 v5, s[8:11], s64 offen offset:1024 lds
    s_waitcnt lgkmcnt(4)
    v_mfma_f32_16x16x32_bf16 v[176:179], v[44:47], v[112:115], v[176:179]
    v_mfma_f32_16x16x32_bf16 v[180:183], v[44:47], v[116:119], v[180:183]
    v_mfma_f32_16x16x32_bf16 v[184:187], v[44:47], v[120:123], v[184:187]
    ds_read_b64_tr_b16 v[40:41], v1 offset:25536
    ds_read_b64_tr_b16 v[42:43], v1 offset:25792
    buffer_load_dwordx4 v[96:99], v6, s[4:7], s63 offen nt
    s_waitcnt lgkmcnt(4)
    v_mfma_f32_16x16x32_bf16 v[192:195], v[32:35], v[112:115], v[192:195]
    v_mfma_f32_16x16x32_bf16 v[196:199], v[32:35], v[116:119], v[196:199]
    v_mfma_f32_16x16x32_bf16 v[200:203], v[32:35], v[120:123], v[200:203]
    ds_read_b64_tr_b16 v[44:45], v1 offset:25568
    ds_read_b64_tr_b16 v[46:47], v1 offset:25824
    s_add_u32 s52, s63, 0x1000
    buffer_load_dwordx4 v[100:103], v6, s[4:7], s52 offen nt
    s_waitcnt lgkmcnt(4)
    v_mfma_f32_16x16x32_bf16 v[208:211], v[36:39], v[112:115], v[208:211]
    v_mfma_f32_16x16x32_bf16 v[212:215], v[36:39], v[116:119], v[212:215]
    v_mfma_f32_16x16x32_bf16 v[216:219], v[36:39], v[120:123], v[216:219]
    ds_read_b64_tr_b16 v[32:33], v1 offset:0
    ds_read_b64_tr_b16 v[34:35], v1 offset:256
    s_add_u32 s52, s63, 0x2000
    buffer_load_dwordx4 v[104:107], v6, s[4:7], s52 offen nt
    s_waitcnt lgkmcnt(4)
    v_mfma_f32_16x16x32_bf16 v[224:227], v[40:43], v[112:115], v[224:227]
    v_mfma_f32_16x16x32_bf16 v[228:231], v[40:43], v[116:119], v[228:231]
    v_mfma_f32_16x16x32_bf16 v[232:235], v[40:43], v[120:123], v[232:235]
    ds_read_b64_tr_b16 v[36:37], v1 offset:32
    ds_read_b64_tr_b16 v[38:39], v1 offset:288
    s_waitcnt lgkmcnt(4)
    v_mfma_f32_16x16x32_bf16 v[240:243], v[44:47], v[112:115], v[240:243]
    v_mfma_f32_16x16x32_bf16 v[244:247], v[44:47], v[116:119], v[244:247]
    v_mfma_f32_16x16x32_bf16 v[248:251], v[44:47], v[120:123], v[248:251]
    ds_read_b64_tr_b16 v[40:41], v1 offset:64
    ds_read_b64_tr_b16 v[42:43], v1 offset:320
    s_add_u32 s44, s44, 1
    s_cmp_lt_u32 s44, 4
    s_cbranch_scc1 k2_loop_3
    s_waitcnt vmcnt(0) lgkmcnt(0)
    s_barrier
    v_lshlrev_b32 v7, 4, v0
    s_lshl_b32 s26, s27, 13
    v_add_u32 v7, s26, v7
    s_cmp_eq_u32 s67, 0
    s_cbranch_scc0 k2_g1_3
    ds_write_b128 v7, v[192:195] offset:4096
    ds_write_b128 v7, v[208:211] offset:5120
    ds_write_b128 v7, v[224:227] offset:6144
    ds_write_b128 v7, v[240:243] offset:7168
    ds_write_b128 v7, v[196:199] offset:12288
    ds_write_b128 v7, v[212:215] offset:13312
    ds_write_b128 v7, v[228:231] offset:14336
    ds_write_b128 v7, v[244:247] offset:15360
    ds_write_b128 v7, v[200:203] offset:20480
    ds_write_b128 v7, v[216:219] offset:21504
    ds_write_b128 v7, v[232:235] offset:22528
    ds_write_b128 v7, v[248:251] offset:23552
    s_waitcnt lgkmcnt(0)
    s_barrier
    ds_read_b128 v[64:67], v7 offset:0
    ds_read_b128 v[68:71], v7 offset:1024
    ds_read_b128 v[72:75], v7 offset:2048
    ds_read_b128 v[76:79], v7 offset:3072
    ds_read_b128 v[80:83], v7 offset:8192
    ds_read_b128 v[84:87], v7 offset:9216
    ds_read_b128 v[88:91], v7 offset:10240
    ds_read_b128 v[92:95], v7 offset:11264
    ds_read_b128 v[96:99], v7 offset:16384
    ds_read_b128 v[100:103], v7 offset:17408
    ds_read_b128 v[104:107], v7 offset:18432
    ds_read_b128 v[108:111], v7 offset:19456
    s_waitcnt lgkmcnt(8)
    v_add_f32 v128, v128, v64
    v_add_f32 v129, v129, v65
    v_add_f32 v130, v130, v66
    v_add_f32 v131, v131, v67
    v_add_f32 v144, v144, v68
    v_add_f32 v145, v145, v69
    v_add_f32 v146, v146, v70
    v_add_f32 v147, v147, v71
    v_add_f32 v160, v160, v72
    v_add_f32 v161, v161, v73
    v_add_f32 v162, v162, v74
    v_add_f32 v163, v163, v75
    v_add_f32 v176, v176, v76
    v_add_f32 v177, v177, v77
    v_add_f32 v178, v178, v78
    v_add_f32 v179, v179, v79
    s_mov_b32 s52, 0
    buffer_store_dwordx4 v[128:131], v7, s[20:23], s52 offen
    buffer_store_dwordx4 v[144:147], v7, s[20:23], s52 offen offset:1024
    buffer_store_dwordx4 v[160:163], v7, s[20:23], s52 offen offset:2048
    buffer_store_dwordx4 v[176:179], v7, s[20:23], s52 offen offset:3072
    s_waitcnt lgkmcnt(4)
    v_add_f32 v132, v132, v80
    v_add_f32 v133, v133, v81
    v_add_f32 v134, v134, v82
    v_add_f32 v135, v135, v83
    v_add_f32 v148, v148, v84
    v_add_f32 v149, v149, v85
    v_add_f32 v150, v150, v86
    v_add_f32 v151, v151, v87
    v_add_f32 v164, v164, v88
    v_add_f32 v165, v165, v89
    v_add_f32 v166, v166, v90
    v_add_f32 v167, v167, v91
    v_add_f32 v180, v180, v92
    v_add_f32 v181, v181, v93
    v_add_f32 v182, v182, v94
    v_add_f32 v183, v183, v95
    s_mov_b32 s52, 0x2000
    buffer_store_dwordx4 v[132:135], v7, s[20:23], s52 offen
    buffer_store_dwordx4 v[148:151], v7, s[20:23], s52 offen offset:1024
    buffer_store_dwordx4 v[164:167], v7, s[20:23], s52 offen offset:2048
    buffer_store_dwordx4 v[180:183], v7, s[20:23], s52 offen offset:3072
    s_waitcnt lgkmcnt(0)
    v_add_f32 v136, v136, v96
    v_add_f32 v137, v137, v97
    v_add_f32 v138, v138, v98
    v_add_f32 v139, v139, v99
    v_add_f32 v152, v152, v100
    v_add_f32 v153, v153, v101
    v_add_f32 v154, v154, v102
    v_add_f32 v155, v155, v103
    v_add_f32 v168, v168, v104
    v_add_f32 v169, v169, v105
    v_add_f32 v170, v170, v106
    v_add_f32 v171, v171, v107
    v_add_f32 v184, v184, v108
    v_add_f32 v185, v185, v109
    v_add_f32 v186, v186, v110
    v_add_f32 v187, v187, v111
    s_mov_b32 s52, 0x4000
    buffer_store_dwordx4 v[136:139], v7, s[20:23], s52 offen
    buffer_store_dwordx4 v[152:155], v7, s[20:23], s52 offen offset:1024
    buffer_store_dwordx4 v[168:171], v7, s[20:23], s52 offen offset:2048
    buffer_store_dwordx4 v[184:187], v7, s[20:23], s52 offen offset:3072
    s_endpgm
k2_g1_3:
    ds_write_b128 v7, v[128:131] offset:0
    ds_write_b128 v7, v[144:147] offset:1024
    ds_write_b128 v7, v[160:163] offset:2048
    ds_write_b128 v7, v[176:179] offset:3072
    ds_write_b128 v7, v[132:135] offset:8192
    ds_write_b128 v7, v[148:151] offset:9216
    ds_write_b128 v7, v[164:167] offset:10240
    ds_write_b128 v7, v[180:183] offset:11264
    ds_write_b128 v7, v[136:139] offset:16384
    ds_write_b128 v7, v[152:155] offset:17408
    ds_write_b128 v7, v[168:171] offset:18432
    ds_write_b128 v7, v[184:187] offset:19456
    s_waitcnt lgkmcnt(0)
    s_barrier
    ds_read_b128 v[64:67], v7 offset:4096
    ds_read_b128 v[68:71], v7 offset:5120
    ds_read_b128 v[72:75], v7 offset:6144
    ds_read_b128 v[76:79], v7 offset:7168
    ds_read_b128 v[80:83], v7 offset:12288
    ds_read_b128 v[84:87], v7 offset:13312
    ds_read_b128 v[88:91], v7 offset:14336
    ds_read_b128 v[92:95], v7 offset:15360
    ds_read_b128 v[96:99], v7 offset:20480
    ds_read_b128 v[100:103], v7 offset:21504
    ds_read_b128 v[104:107], v7 offset:22528
    ds_read_b128 v[108:111], v7 offset:23552
    s_waitcnt lgkmcnt(8)
    v_add_f32 v192, v192, v64
    v_add_f32 v193, v193, v65
    v_add_f32 v194, v194, v66
    v_add_f32 v195, v195, v67
    v_add_f32 v208, v208, v68
    v_add_f32 v209, v209, v69
    v_add_f32 v210, v210, v70
    v_add_f32 v211, v211, v71
    v_add_f32 v224, v224, v72
    v_add_f32 v225, v225, v73
    v_add_f32 v226, v226, v74
    v_add_f32 v227, v227, v75
    v_add_f32 v240, v240, v76
    v_add_f32 v241, v241, v77
    v_add_f32 v242, v242, v78
    v_add_f32 v243, v243, v79
    s_mov_b32 s52, 0x1000
    buffer_store_dwordx4 v[192:195], v7, s[20:23], s52 offen
    buffer_store_dwordx4 v[208:211], v7, s[20:23], s52 offen offset:1024
    buffer_store_dwordx4 v[224:227], v7, s[20:23], s52 offen offset:2048
    buffer_store_dwordx4 v[240:243], v7, s[20:23], s52 offen offset:3072
    s_waitcnt lgkmcnt(4)
    v_add_f32 v196, v196, v80
    v_add_f32 v197, v197, v81
    v_add_f32 v198, v198, v82
    v_add_f32 v199, v199, v83
    v_add_f32 v212, v212, v84
    v_add_f32 v213, v213, v85
    v_add_f32 v214, v214, v86
    v_add_f32 v215, v215, v87
    v_add_f32 v228, v228, v88
    v_add_f32 v229, v229, v89
    v_add_f32 v230, v230, v90
    v_add_f32 v231, v231, v91
    v_add_f32 v244, v244, v92
    v_add_f32 v245, v245, v93
    v_add_f32 v246, v246, v94
    v_add_f32 v247, v247, v95
    s_mov_b32 s52, 0x3000
    buffer_store_dwordx4 v[196:199], v7, s[20:23], s52 offen
    buffer_store_dwordx4 v[212:215], v7, s[20:23], s52 offen offset:1024
    buffer_store_dwordx4 v[228:231], v7, s[20:23], s52 offen offset:2048
    buffer_store_dwordx4 v[244:247], v7, s[20:23], s52 offen offset:3072
    s_waitcnt lgkmcnt(0)
    v_add_f32 v200, v200, v96
    v_add_f32 v201, v201, v97
    v_add_f32 v202, v202, v98
    v_add_f32 v203, v203, v99
    v_add_f32 v216, v216, v100
    v_add_f32 v217, v217, v101
    v_add_f32 v218, v218, v102
    v_add_f32 v219, v219, v103
    v_add_f32 v232, v232, v104
    v_add_f32 v233, v233, v105
    v_add_f32 v234, v234, v106
    v_add_f32 v235, v235, v107
    v_add_f32 v248, v248, v108
    v_add_f32 v249, v249, v109
    v_add_f32 v250, v250, v110
    v_add_f32 v251, v251, v111
    s_mov_b32 s52, 0x5000
    buffer_store_dwordx4 v[200:203], v7, s[20:23], s52 offen
    buffer_store_dwordx4 v[216:219], v7, s[20:23], s52 offen offset:1024
    buffer_store_dwordx4 v[232:235], v7, s[20:23], s52 offen offset:2048
    buffer_store_dwordx4 v[248:251], v7, s[20:23], s52 offen offset:3072
    s_endpgm
k2_end:
    s_endpgm

.section .rodata,"a"
.p2align 6
.amdhsa_kernel oproj_kernel
  .amdhsa_next_free_vgpr 256
  .amdhsa_next_free_sgpr 102
  .amdhsa_accum_offset 256
  .amdhsa_group_segment_fixed_size 0
  .amdhsa_kernarg_size 104
  .amdhsa_user_sgpr_count 2
  .amdhsa_user_sgpr_kernarg_segment_ptr 1
  .amdhsa_system_sgpr_workgroup_id_x 1
.end_amdhsa_kernel
.text
.globl reduce_kernel
.p2align 8
.type reduce_kernel,@function
reduce_kernel:
    s_cmp_ge_u32 s2, 0x340
    s_cbranch_scc1 k3_end
    s_load_dwordx2 s[40:41], s[0:1], 0x60
    s_load_dwordx2 s[32:33], s[0:1], 0x50
    s_mul_hi_u32 s28, s2, 0x4ec4ec4f
    s_lshr_b32 s28, s28, 2
    s_mul_i32 s29, s28, 13
    s_sub_u32 s29, s2, s29
    v_lshrrev_b32 v7, 6, v0
    s_nop 0
    v_readfirstlane_b32 s24, v7
    v_and_b32 v0, 63, v0
    s_mul_i32 s30, s28, 0x1a000
    s_lshl_b32 s31, s29, 13
    s_add_u32 s30, s30, s31
    s_lshl_b32 s31, s24, 11
    s_add_u32 s30, s30, s31
    v_lshlrev_b32 v1, 4, v0
    v_add_u32 v1, s30, v1
    s_waitcnt lgkmcnt(0)
    s_add_u32 s4, s40, 0x2000000
    s_addc_u32 s5, s41, 0
    s_and_b32 s5, s5, 0xffff
    s_mov_b32 s6, 0x1a00000
    s_mov_b32 s7, 0x20000
    s_add_u32 s20, s32, 0
    s_addc_u32 s21, s33, 0
    s_and_b32 s21, s21, 0xffff
    s_mov_b32 s22, 0x340000
    s_mov_b32 s23, 0x20000
    s_mov_b32 s52, 0
    buffer_load_dwordx4 v[32:35], v1, s[4:7], s52 offen nt
    buffer_load_dwordx4 v[36:39], v1, s[4:7], s52 offen offset:1024 nt
    s_mov_b32 s52, 0x680000
    buffer_load_dwordx4 v[40:43], v1, s[4:7], s52 offen nt
    buffer_load_dwordx4 v[44:47], v1, s[4:7], s52 offen offset:1024 nt
    s_mov_b32 s52, 0xd00000
    buffer_load_dwordx4 v[48:51], v1, s[4:7], s52 offen nt
    buffer_load_dwordx4 v[52:55], v1, s[4:7], s52 offen offset:1024 nt
    s_mov_b32 s52, 0x1380000
    buffer_load_dwordx4 v[56:59], v1, s[4:7], s52 offen nt
    buffer_load_dwordx4 v[60:63], v1, s[4:7], s52 offen offset:1024 nt
    s_lshr_b32 s55, s28, 5
    s_lshr_b32 s57, s28, 2
    s_and_b32 s57, s57, 7
    s_and_b32 s61, s28, 3
    s_mul_i32 s58, s57, 0xd0
    s_lshl_b32 s59, s29, 4
    s_add_u32 s58, s58, s59
    s_lshl_b32 s58, s58, 11
    s_lshl_b32 s59, s55, 10
    s_add_u32 s58, s58, s59
    s_lshl_b32 s59, s61, 8
    s_add_u32 s58, s58, s59
    s_lshl_b32 s59, s24, 6
    s_add_u32 s58, s58, s59
    v_and_b32 v11, 15, v0
    v_mul_u32_u24 v11, 0x800, v11
    v_add_u32 v11, s58, v11
    v_lshrrev_b32 v10, 4, v0
    v_and_b32 v10, 1, v10
    v_lshlrev_b32 v10, 1, v10
    v_lshrrev_b32 v9, 4, v0
    v_lshrrev_b32 v9, 1, v9
    v_or_b32 v10, v10, v9
    v_mul_u32_u24 v10, 16, v10
    v_add_u32 v2, v11, v10
    s_waitcnt vmcnt(0)
    v_add_f32 v32, v32, v40
    v_add_f32 v48, v48, v56
    v_add_f32 v33, v33, v41
    v_add_f32 v49, v49, v57
    v_add_f32 v34, v34, v42
    v_add_f32 v50, v50, v58
    v_add_f32 v35, v35, v43
    v_add_f32 v51, v51, v59
    v_add_f32 v36, v36, v44
    v_add_f32 v52, v52, v60
    v_add_f32 v37, v37, v45
    v_add_f32 v53, v53, v61
    v_add_f32 v38, v38, v46
    v_add_f32 v54, v54, v62
    v_add_f32 v39, v39, v47
    v_add_f32 v55, v55, v63
    v_add_f32 v32, v32, v48
    v_add_f32 v33, v33, v49
    v_add_f32 v34, v34, v50
    v_add_f32 v35, v35, v51
    v_add_f32 v36, v36, v52
    v_add_f32 v37, v37, v53
    v_add_f32 v38, v38, v54
    v_add_f32 v39, v39, v55
    v_cvt_pk_bf16_f32 v20, v32, v33
    v_cvt_pk_bf16_f32 v21, v34, v35
    v_cvt_pk_bf16_f32 v22, v36, v37
    v_cvt_pk_bf16_f32 v23, v38, v39
    s_nop 0
    v_permlane16_swap_b32 v20, v22
    v_permlane16_swap_b32 v21, v23
    buffer_store_dwordx4 v[20:23], v2, s[20:23], 0 offen
k3_end:
    s_endpgm

.section .rodata,"a"
.p2align 6
.amdhsa_kernel reduce_kernel
  .amdhsa_next_free_vgpr 64
  .amdhsa_next_free_sgpr 102
  .amdhsa_accum_offset 64
  .amdhsa_group_segment_fixed_size 0
  .amdhsa_kernarg_size 104
  .amdhsa_user_sgpr_count 2
  .amdhsa_user_sgpr_kernarg_segment_ptr 1
  .amdhsa_system_sgpr_workgroup_id_x 1
.end_amdhsa_kernel
```
